```python
import torch

def _softmax(x, axis=-1):
    return torch.softmax(x, dim=axis)
def _gelu(x):
    return torch.nn.functional.gelu(x, approximate="tanh")
def _silu(x):
    return torch.nn.functional.silu(x)
def _sigmoid(x):
    return torch.sigmoid(x)
def _layernorm(x, axis=-1, eps=1e-5):
    m = x.mean(dim=axis, keepdim=True)
    v = x.var(dim=axis, keepdim=True, unbiased=False)
    return (x - m) / torch.sqrt(v + eps)
def _scatter_add(tgt, idx, src, axis=0):
    return tgt.clone().index_add_(axis, idx, src)
def _segment_sum(src, seg, n):
    out = torch.zeros((n,) + src.shape[1:], dtype=src.dtype)
    return out.index_add_(0, seg, src)
def _pad(x, pw):
    flat = tuple(v for pair in reversed(pw) for v in pair)
    return torch.nn.functional.pad(x, flat)

kernel_name = 'sequential_preLN__linear_attn_block__geglu_ffn__prompt'

def setup_inputs():

    _w = (lambda a: (lambda t: t.to(torch.bfloat16) if t.is_floating_point() else t)(torch.as_tensor(a)))
    def _A_setup():
        B, S, D = 1, 2048, 512
        return {
            "x": _w((lambda *s: torch.randn(*s, dtype=torch.bfloat16) * 0.05)(B, S, D)),
            "wqkv": _w((lambda *s: torch.randn(*s, dtype=torch.bfloat16) * 0.05)(D, 3 * D)),
            "wo": _w((lambda *s: torch.randn(*s, dtype=torch.bfloat16) * 0.05)(D, D)),
        }
    _A_in = _A_setup()

    def _B_setup():
        B, S, D, F = 1, 2048, 512, 1376
        return {
            "x": _w((lambda *s: torch.randn(*s, dtype=torch.bfloat16) * 0.05)(B, S, D)),
            "w_gate": _w((lambda *s: torch.randn(*s, dtype=torch.bfloat16) * 0.05)(D, F)),
            "w_up": _w((lambda *s: torch.randn(*s, dtype=torch.bfloat16) * 0.05)(D, F)),
            "w_down": _w((lambda *s: torch.randn(*s, dtype=torch.bfloat16) * 0.05)(F, D)),
        }
    _B_in = _B_setup()

    return {
        "A_x": _A_in["x"],
        "A_wqkv": _A_in["wqkv"],
        "A_wo": _A_in["wo"],
        "B_x": _B_in["x"],
        "B_w_gate": _B_in["w_gate"],
        "B_w_up": _B_in["w_up"],
        "B_w_down": _B_in["w_down"],
    }

def reference(A_x, A_wqkv, A_wo, B_x, B_w_gate, B_w_up, B_w_down):
    def _A_ref(x, wqkv, wo):
        B, S, D = x.shape
        H = 32; Dh = D // H
        qkv = (lambda x, *d: x.permute(*d))((x @ wqkv).reshape(B, S, 3, H, Dh), 2, 0, 3, 1, 4)
        q, k, v = qkv[0], qkv[1], qkv[2]
        phi = lambda t: torch.where(t > 0, t + 1, torch.exp(t)) + 1e-6
        pq, pk = phi(q), phi(k)
        kv = torch.einsum("bhsd,bhse->bhde", pk, v)
        z = torch.einsum("bhsd->bhd", pk)
        num = torch.einsum("bhqd,bhde->bhqe", pq, kv)
        den = torch.einsum("bhqd,bhd->bhq", pq, z)[..., None] + 1e-6
        o = num / den
        return (lambda x, *d: x.permute(*d))(o, 0, 2, 1, 3).reshape(B, S, D) @ wo

    def _B_ref(x, w_gate, w_up, w_down):
        return (_gelu(x @ w_gate) * (x @ w_up)) @ w_down

    x = A_x
    h = x + _A_ref(_layernorm(x, axis=-1), A_wqkv, A_wo)
    h2 = h + _B_ref(_layernorm(h, axis=-1), B_w_gate, B_w_up, B_w_down)
    return h2
```

```asm
; @launch grid=(256,1,1) block=(256,1,1) lds=163840
.amdgcn_target "amdgcn-amd-amdhsa--gfx950"
.text
.globl sequential_preLN__linear_attn_block__geglu_ffn__prompt_kernel
.p2align 8
.type sequential_preLN__linear_attn_block__geglu_ffn__prompt_kernel,@function
sequential_preLN__linear_attn_block__geglu_ffn__prompt_kernel:
    s_load_dwordx4 s[48:51], s[0:1], 0
    s_load_dwordx2 s[64:65], s[0:1], 72
    s_load_dwordx2 s[52:53], s[0:1], 16
    s_load_dwordx4 s[56:59], s[0:1], 32
    s_load_dwordx4 s[60:63], s[0:1], 48
    s_cmp_ge_u32 s2, 256
    s_cbranch_scc1 L_end
    v_lshrrev_b32 v6, 6, v0
    v_and_b32 v1, 63, v0
    v_readfirstlane_b32 s36, v6
    s_and_b32 s37, s2, 7
    s_lshr_b32 s66, s2, 3
    s_and_b32 s39, s66, 7
    s_lshr_b32 s40, s66, 3
    s_lshl_b32 s41, s37, 2
    s_add_u32 s41, s41, s40
    s_getpc_b64 s[100:101]
L_pc:
    s_lshl_b32 s66, s66, 2
    s_add_u32 s66, s66, s36
    s_min_u32 s66, s66, (L_end-L_pc)/1024-1
    s_lshl_b32 s66, s66, 10
    v_lshl_add_u32 v7, v1, 4, s66
    global_load_dwordx4 v[244:247], v7, s[100:101]
    v_lshrrev_b32 v24, 4, v1
    v_lshrrev_b32 v26, 3, v1
    v_and_b32 v27, 7, v1
    v_xor_b32 v47, v27, v24
    v_lshlrev_b32 v46, 10, v26
    v_lshl_add_u32 v46, v47, 4, v46
    v_xor_b32 v47, 64, v46
    v_add_u32 v47, 8192, v47
    s_lshl_b32 s54, s41, 2
    s_add_u32 s54, s54, s36
    s_lshl_b32 s54, s54, 14
    s_lshl_b32 s44, s40, 1
    s_add_u32 s44, s44, s39
    s_lshl_b32 s47, s36, 11
    v_and_b32 v25, 1, v24
    v_lshlrev_b32 v25, 2, v25
    v_xor_b32 v27, v27, v25
    v_lshlrev_b32 v27, 4, v27
    v_mul_u32_u24 v16, 3072, v26
    v_add_u32 v16, v16, v27
    s_mul_i32 s66, s36, 49152
    s_lshl_b32 s67, s39, 7
    s_add_u32 s66, s66, s67
    v_add_u32 v16, s66, v16
    v_add_u32 v8, 1024, v16
    v_add_u32 v9, 25600, v16
    v_add_u32 v14, 2048, v16
    v_add_u32 v15, 26624, v16
    s_add_u32 s66, s44, 0
    s_and_b32 s66, s66, 7
    s_mul_i32 s84, s66, 196608
    s_lshl_b32 s66, s66, 7
    s_add_u32 s92, s66, s54
    s_add_u32 s66, s44, 1
    s_and_b32 s66, s66, 7
    s_mul_i32 s85, s66, 196608
    s_lshl_b32 s66, s66, 7
    s_add_u32 s93, s66, s54
    s_waitcnt lgkmcnt(0)
    s_load_dwordx2 s[42:43], s[64:65], 0
    s_mov_b32 s4, s48
    s_and_b32 s5, s49, 0xffff
    s_mov_b32 s6, 0x200000
    s_mov_b32 s7, 0x00020000
    s_add_u32 m0, s47, 0
    s_nop 0
    buffer_load_dwordx4 v46, s[4:7], s92 offen nt lds
    s_add_u32 m0, s47, 1024
    s_nop 0
    buffer_load_dwordx4 v47, s[4:7], s92 offen nt lds
    s_mov_b32 s8, s50
    s_and_b32 s9, s51, 0xffff
    s_mov_b32 s10, 0x180000
    s_mov_b32 s11, 0x00020000
    s_add_u32 m0, s47, 65536
    s_nop 0
    buffer_load_dwordx4 v8, s[8:11], s84 offen  lds
    s_add_u32 m0, s47, 66560
    s_nop 0
    buffer_load_dwordx4 v9, s[8:11], s84 offen  lds
    s_add_u32 m0, s47, 73728
    s_nop 0
    buffer_load_dwordx4 v14, s[8:11], s84 offen  lds
    s_add_u32 m0, s47, 74752
    s_nop 0
    buffer_load_dwordx4 v15, s[8:11], s84 offen  lds
    s_add_u32 m0, s47, 8192
    s_nop 0
    buffer_load_dwordx4 v46, s[4:7], s93 offen nt lds
    s_add_u32 m0, s47, 9216
    s_nop 0
    buffer_load_dwordx4 v47, s[4:7], s93 offen nt lds
    s_add_u32 m0, s47, 81920
    s_nop 0
    buffer_load_dwordx4 v8, s[8:11], s85 offen  lds
    s_add_u32 m0, s47, 82944
    s_nop 0
    buffer_load_dwordx4 v9, s[8:11], s85 offen  lds
    s_add_u32 m0, s47, 90112
    s_nop 0
    buffer_load_dwordx4 v14, s[8:11], s85 offen  lds
    s_add_u32 m0, s47, 91136
    s_nop 0
    buffer_load_dwordx4 v15, s[8:11], s85 offen  lds
    s_add_u32 s66, s44, 2
    s_and_b32 s66, s66, 7
    s_mul_i32 s86, s66, 196608
    s_lshl_b32 s66, s66, 7
    s_add_u32 s94, s66, s54
    s_add_u32 s66, s44, 3
    s_and_b32 s66, s66, 7
    s_mul_i32 s87, s66, 196608
    s_lshl_b32 s66, s66, 7
    s_add_u32 s95, s66, s54
    s_add_u32 s66, s44, 4
    s_and_b32 s66, s66, 7
    s_mul_i32 s88, s66, 196608
    s_lshl_b32 s66, s66, 7
    s_add_u32 s96, s66, s54
    s_add_u32 s66, s44, 5
    s_and_b32 s66, s66, 7
    s_mul_i32 s89, s66, 196608
    s_lshl_b32 s66, s66, 7
    s_add_u32 s97, s66, s54
    s_add_u32 s66, s44, 6
    s_and_b32 s66, s66, 7
    s_mul_i32 s90, s66, 196608
    s_lshl_b32 s66, s66, 7
    s_add_u32 s98, s66, s54
    s_add_u32 s66, s44, 7
    s_and_b32 s66, s66, 7
    s_mul_i32 s91, s66, 196608
    s_lshl_b32 s66, s66, 7
    s_add_u32 s99, s66, s54
    s_mov_b32 s12, s52
    s_and_b32 s13, s53, 0xffff
    s_mov_b32 s14, 0x80000
    s_mov_b32 s15, 0x00020000
    s_and_b32 s45, s36, 1
    s_lshr_b32 s46, s36, 1
    v_lshlrev_b32 v2, 4, v1
    s_lshl_b32 s3, s41, 1
    s_add_u32 s3, s3, s45
    s_lshl_b32 s53, s39, 6
    s_add_u32 s53, s53, s3
    s_lshl_b32 s53, s53, 10
    s_lshr_b32 s67, s3, 5
    s_cmp_eq_u32 s67, s46
    s_cselect_b32 s53, s53, 0x7f000000
    buffer_load_dwordx4 v[60:63], v2, s[12:15], s53 offen
    s_mov_b32 s32, s64
    s_and_b32 s33, s65, 0xffff
    s_mov_b32 s34, 0x1100000
    s_mov_b32 s35, 0x00020000
    s_mov_b32 s16, s56
    s_and_b32 s17, s57, 0xffff
    s_mov_b32 s18, 0x158000
    s_mov_b32 s19, 0x00020000
    s_mov_b32 s20, s58
    s_and_b32 s21, s59, 0xffff
    s_mov_b32 s22, 0x158000
    s_mov_b32 s23, 0x00020000
    s_mov_b32 s24, s60
    s_and_b32 s25, s61, 0xffff
    s_mov_b32 s26, 0x158000
    s_mov_b32 s27, 0x00020000
    s_mov_b32 s28, s62
    s_and_b32 s29, s63, 0xffff
    s_mov_b32 s30, 0x200000
    s_mov_b32 s31, 0x00020000
    v_mov_b32 v3, 0
    s_mov_b32 s69, 0xffff0000
    v_add_u32 v17, 24576, v16
    v_lshl_add_u32 v11, v26, 10, v27
    v_mul_u32_u24 v12, 2752, v26
    v_add_u32 v12, v12, v27
    s_mul_i32 s66, s41, 49152
    s_mul_i32 s67, s39, 6144
    s_add_u32 s66, s66, s67
    s_mul_i32 s67, s36, 1536
    s_add_u32 s66, s66, s67
    s_add_u32 s66, s66, 262144
    s_cmp_lt_u32 s41, 2
    s_cselect_b32 s66, s66, 0x7f000000
    v_mov_b32 v28, 0
    v_mov_b32 v29, 0
    v_mov_b32 v30, 0
    v_mov_b32 v31, 0
    v_lshlrev_b32 v23, 3, v1
    buffer_store_dwordx4 v[28:31], v2, s[32:35], s66 offen sc1
    buffer_store_dwordx2 v[28:29], v23, s[32:35], s66 offen offset:1024 sc1
    v_bfe_u32 v24, v1, 2, 2
    v_bfe_u32 v25, v1, 1, 1
    v_bfe_u32 v26, v1, 4, 1
    v_lshl_add_u32 v25, v26, 1, v25
    v_bfe_u32 v26, v1, 3, 1
    v_lshlrev_b32 v26, 2, v26
    v_lshlrev_b32 v24, 7, v24
    v_and_b32 v27, 1, v1
    v_lshl_add_u32 v24, v27, 3, v24
    v_lshrrev_b32 v27, 5, v1
    s_lshl_b32 s66, s46, 2
    v_add_u32 v32, s66, v25
    v_xor_b32 v32, v32, v26
    v_lshl_add_u32 v32, v32, 4, v24
    v_lshl_add_u32 v34, v27, 10, v32
    v_lshl_add_u32 v13, v27, 9, v32
    s_lshl_b32 s66, s45, 1
    s_add_u32 s58, s66, s46
    s_lshl_b32 s66, s58, 11
    v_add_u32 v124, s66, v34
    v_xor_b32 v125, 2048, v124
    v_xor_b32 v126, 4096, v124
    v_xor_b32 v127, 6144, v124
    v_add_u32 v120, 65536, v124
    v_add_u32 v121, 65536, v125
    v_add_u32 v122, 65536, v126
    v_add_u32 v123, 65536, v127
    v_bfe_u32 v33, v1, 1, 1
    v_xor_b32 v33, v33, v26
    v_lshl_add_u32 v33, v33, 4, v24
    v_lshl_add_u32 v33, v27, 9, v33
    v_bfe_u32 v20, v1, 4, 1
    v_lshl_add_u32 v20, v20, 11, v33
    v_xor_b32 v21, v25, v26
    v_lshl_add_u32 v21, v21, 4, v24
    v_lshl_add_u32 v21, v27, 9, v21
    s_mul_i32 s66, s36, 6144
    s_add_u32 s66, s66, 98304
    v_add_u32 v20, s66, v20
    v_add_u32 v21, s66, v21
    v_and_b32 v35, 31, v1
    s_lshl_b32 s66, s45, 5
    v_add_u32 v32, s66, v35
    v_bfe_u32 v33, v32, 1, 3
    v_lshlrev_b32 v32, 7, v32
    s_lshl_b32 s66, s58, 1
    v_xor_b32 v34, s66, v33
    v_xor_b32 v34, v34, v27
    v_lshl_add_u32 v116, v34, 4, v32
    v_xor_b32 v117, 32, v116
    v_xor_b32 v118, 64, v116
    v_xor_b32 v119, 0x60, v116
    s_lshl_b32 s66, s46, 2
    v_xor_b32 v33, s66, v33
    v_lshl_add_u32 v10, v33, 4, v32
    v_lshl_add_u32 v10, v27, 3, v10
    v_add_u32 v10, 147456, v10
    v_mov_b32 v22, 0x3f803f80
    v_lshrrev_b32 v32, 2, v1
    v_xor_b32 v32, v32, v1
    v_and_b32 v32, 4, v32
    v_cmp_eq_u32 vcc, 0, v32
    s_nop 1
    v_cndmask_b32 v112, 0, v22, vcc
    v_mov_b32 v113, v112
    v_mov_b32 v114, v112
    v_mov_b32 v115, v112
    v_mov_b32 v97, 0
    v_mov_b32 v98, 0
    v_mov_b32 v99, 0
    v_mov_b32 v101, 0
    v_mov_b32 v102, 0
    v_mov_b32 v103, 0
    v_mov_b32 v105, 0
    v_mov_b32 v106, 0
    v_mov_b32 v107, 0
    v_mov_b32 v109, 0
    v_mov_b32 v110, 0
    v_mov_b32 v111, 0
    s_mul_i32 s66, s36, 512
    s_add_u32 s66, s66, 155648
    v_lshl_add_u32 v40, v35, 2, s66
    v_xor_b32 v41, 512, v40
    v_xor_b32 v42, 1024, v40
    v_lshl_add_u32 v43, v27, 4, s66
    s_mul_i32 s52, s45, 6144
    s_mul_i32 s53, s46, 3072
    s_add_u32 s52, s52, s53
    s_add_u32 s52, s52, 81920
    v_add_u32 v176, s52, v2
    v_bfe_u32 v32, v1, 2, 1
    v_lshlrev_b32 v32, 5, v32
    v_and_b32 v33, 0x13, v1
    v_add_u32 v32, v32, v33
    v_bfe_u32 v33, v1, 3, 1
    v_lshl_add_u32 v32, v33, 2, v32
    v_lshl_add_u32 v32, v27, 3, v32
    v_lshlrev_b32 v32, 4, v32
    v_add_u32 v177, s52, v32
    s_mul_i32 s52, s36, 1536
    s_add_u32 s53, s52, 81920
    v_lshlrev_b32 v178, 2, v1
    v_add_u32 v179, s53, v178
    s_and_b32 s53, s41, 1
    s_mul_i32 s53, s53, 49152
    s_mul_i32 s66, s39, 6144
    s_add_u32 s53, s53, s66
    s_add_u32 s53, s53, s52
    s_add_u32 s55, s53, 262144
    v_mov_b32 v188, v22
    v_mov_b32 v189, v22
    v_mov_b32 v190, v22
    v_mov_b32 v191, v22
    v_mov_b32 v131, 0.5
    v_mov_b32 v135, 0.5
    v_mov_b32 v139, 0.5
    v_mov_b32 v182, 0x3fb8aa3b
    v_mov_b32 v183, 0x358637bd
    s_lshl_b32 s52, s39, 1
    s_and_b32 s53, s41, 1
    s_add_u32 s52, s52, s53
    s_lshl_b32 s52, s52, 6
    s_add_u32 s56, s52, 4096
    v_and_b32 v180, 3, v1
    v_lshlrev_b32 v180, 3, v180
    s_lshl_b32 s57, s37, 9
    s_add_u32 s57, s57, 24576
    v_and_b32 v181, 0x1f0, v2
    s_and_b32 s52, s3, 31
    s_add_u32 s52, s52, 32
    v_cmp_eq_u32 s[62:63], s52, v1
    v_cmp_gt_u32 s[64:65], 32, v1
    s_lshl_b32 s60, s39, 7
    s_add_u32 s60, s60, s54
    s_lshl_b32 s48, s39, 2
    s_add_u32 s48, s48, s36
    s_mul_i32 s49, s48, 96
    s_mul_i32 s50, s41, 44032
    s_add_u32 s49, s49, s50
    s_cmp_lt_u32 s48, 29
    s_cselect_b32 s49, s49, 0x7f000000
    s_add_u32 s50, s49, 22016
    s_lshl_b32 s51, s41, 2
    s_add_u32 s51, s51, s36
    s_lshl_b32 s52, s51, 14
    s_lshl_b32 s53, s39, 7
    s_add_u32 s52, s52, s53
    s_add_u32 s53, s52, 8192
    s_mul_i32 s3, s36, 6144
    s_waitcnt lgkmcnt(0)
    s_mul_i32 s42, s42, 1664525
    s_add_u32 s42, s42, 1013904223
    s_mul_i32 s43, s43, 22695477
    s_add_u32 s43, s43, 0x3c6ef35f
    v_mov_b32 v4, s42
    v_mov_b32 v5, s43
    s_getreg_b32 s38, hwreg(HW_REG_XCC_ID, 0, 4)
    v_mov_b32 v28, s42
    v_mov_b32 v29, s43
    v_mov_b32 v30, s38
    s_lshr_b32 s66, s2, 3
    s_lshl_b32 s67, s37, 5
    s_add_u32 s66, s66, s67
    s_lshl_b32 s66, s66, 4
    s_add_u32 s66, s66, 24576
    s_cmp_eq_u32 s36, 0
    s_cselect_b32 s66, s66, 0x7f000000
    s_mov_b64 exec, 1
    buffer_store_dwordx4 v[28:31], v3, s[32:35], s66 offen sc1
    s_mov_b64 exec, -1
    s_nop 0
    v_min_u32 v28, 11, v1
    v_lshlrev_b32 v28, 7, v28
    s_mul_i32 s66, s41, 1536
    s_add_u32 s66, s66, 32768
    v_add_u32 v251, s66, v28
    s_lshl_b32 s66, s41, 6
    s_add_u32 s66, s66, 8192
    v_writelane_b32 v251, s66, 12
    s_lshr_b32 s66, s40, 1
    s_lshl_b32 s66, s66, 2
    s_lshl_b32 s67, s37, 3
    s_add_u32 s66, s66, s67
    s_add_u32 s66, s66, s36
    s_lshl_b32 s66, s66, 7
    s_add_u32 s66, s66, 12288
    v_writelane_b32 v251, s66, 13
    buffer_load_dword v252, v251, s[32:35], 0 offen sc1
    s_add_u32 m0, s47, 16384
    s_nop 0
    buffer_load_dwordx4 v46, s[4:7], s94 offen nt lds
    s_add_u32 m0, s47, 17408
    s_nop 0
    buffer_load_dwordx4 v47, s[4:7], s94 offen nt lds
    s_add_u32 m0, s47, 24576
    s_nop 0
    buffer_load_dwordx4 v46, s[4:7], s95 offen nt lds
    s_add_u32 m0, s47, 25600
    s_nop 0
    buffer_load_dwordx4 v47, s[4:7], s95 offen nt lds
    s_lshl_b32 s66, s39, 1
    s_add_u32 s66, s66, s41
    s_lshl_b32 s66, s66, 3
    s_add_u32 s66, s66, s36
    s_lshl_b32 s66, s66, 3
    s_add_u32 s66, s66, 4096
    s_cmp_lt_u32 s41, 2
    s_cselect_b32 s59, s66, 0x7f000000
    s_waitcnt vmcnt(15)
    s_barrier
    ds_read_b128 a[0:3], v116 offset:0
    ds_read_b64_tr_b16 v[32:33], v120 offset:0
    ds_read_b64_tr_b16 v[34:35], v120 offset:512
    ds_read_b64_tr_b16 v[36:37], v120 offset:8192
    ds_read_b64_tr_b16 v[38:39], v120 offset:8704
    ds_read_b128 a[4:7], v117 offset:0
    ds_read_b64_tr_b16 v[24:25], v121 offset:0
    ds_read_b64_tr_b16 v[26:27], v121 offset:512
    s_waitcnt lgkmcnt(5)
    s_add_u32 m0, s47, 32768
    v_mfma_f32_32x32x16_bf16 v[192:207], a[0:3], v[32:35], 0
    buffer_load_dwordx4 v46, s[4:7], s96 offen nt lds
    ds_read_b64_tr_b16 v[28:29], v121 offset:8192
    ds_read_b64_tr_b16 v[30:31], v121 offset:8704
    s_waitcnt lgkmcnt(5)
    s_add_u32 m0, s47, 33792
    v_mfma_f32_16x16x32_bf16 v[80:83], v[112:115], v[32:35], 0
    v_mfma_f32_32x32x16_bf16 v[208:223], a[0:3], v[36:39], 0
    buffer_load_dwordx4 v47, s[4:7], s96 offen nt lds
    ds_read_b128 a[8:11], v118 offset:0
    ds_read_b64_tr_b16 v[32:33], v122 offset:0
    ds_read_b64_tr_b16 v[34:35], v122 offset:512
    s_waitcnt lgkmcnt(5)
    s_add_u32 m0, s47, 40960
    v_mfma_f32_16x16x32_bf16 v[148:151], v[112:115], v[36:39], 0
    v_mfma_f32_4x4x4_16b_bf16 v[88:91], a[0:1], a[0:1], 0
    v_mfma_f32_16x16x32_bf16 v[84:87], v[112:115], a[0:3], 0
    v_mfma_f32_4x4x4_16b_bf16 v[92:95], a[2:3], a[2:3], 0
    v_mfma_f32_32x32x16_bf16 v[192:207], a[4:7], v[24:27], v[192:207]
    buffer_load_dwordx4 v46, s[4:7], s97 offen nt lds
    ds_read_b64_tr_b16 v[36:37], v122 offset:8192
    ds_read_b64_tr_b16 v[38:39], v122 offset:8704
    s_waitcnt lgkmcnt(5)
    s_add_u32 m0, s47, 41984
    v_mfma_f32_16x16x32_bf16 v[80:83], v[112:115], v[24:27], v[80:83]
    v_mfma_f32_32x32x16_bf16 v[208:223], a[4:7], v[28:31], v[208:223]
    buffer_load_dwordx4 v47, s[4:7], s97 offen nt lds
    ds_read_b128 a[12:15], v119 offset:0
    ds_read_b64_tr_b16 v[24:25], v123 offset:0
    ds_read_b64_tr_b16 v[26:27], v123 offset:512
    s_waitcnt lgkmcnt(5)
    s_add_u32 m0, s47, 49152
    v_mfma_f32_16x16x32_bf16 v[148:151], v[112:115], v[28:31], v[148:151]
    v_mfma_f32_32x32x16_bf16 v[192:207], a[8:11], v[32:35], v[192:207]
    buffer_load_dwordx4 v46, s[4:7], s98 offen nt lds
    ds_read_b64_tr_b16 v[28:29], v123 offset:8192
    ds_read_b64_tr_b16 v[30:31], v123 offset:8704
    s_waitcnt lgkmcnt(5)
    s_add_u32 m0, s47, 50176
    v_mfma_f32_16x16x32_bf16 v[80:83], v[112:115], v[32:35], v[80:83]
    v_mfma_f32_32x32x16_bf16 v[208:223], a[8:11], v[36:39], v[208:223]
    buffer_load_dwordx4 v47, s[4:7], s98 offen nt lds
    s_waitcnt vmcnt(15)
    s_barrier
    ds_read_b128 a[16:19], v116 offset:8192
    ds_read_b64_tr_b16 v[32:33], v120 offset:16384
    ds_read_b64_tr_b16 v[34:35], v120 offset:16896
    s_waitcnt lgkmcnt(5)
    s_add_u32 m0, s47, 57344
    v_mfma_f32_4x4x4_16b_bf16 v[88:91], a[8:9], a[8:9], v[88:91]
    v_mfma_f32_16x16x32_bf16 v[84:87], v[112:115], a[8:11], v[84:87]
    v_mfma_f32_4x4x4_16b_bf16 v[92:95], a[10:11], a[10:11], v[92:95]
    v_mfma_f32_32x32x16_bf16 v[192:207], a[12:15], v[24:27], v[192:207]
    buffer_load_dwordx4 v46, s[4:7], s99 offen nt lds
    ds_read_b64_tr_b16 v[36:37], v120 offset:24576
    ds_read_b64_tr_b16 v[38:39], v120 offset:25088
    s_waitcnt lgkmcnt(5)
    s_add_u32 m0, s47, 58368
    v_mfma_f32_16x16x32_bf16 v[80:83], v[112:115], v[24:27], v[80:83]
    v_mfma_f32_32x32x16_bf16 v[208:223], a[12:15], v[28:31], v[208:223]
    buffer_load_dwordx4 v47, s[4:7], s99 offen nt lds
    ds_read_b128 a[20:23], v117 offset:8192
    ds_read_b64_tr_b16 v[24:25], v121 offset:16384
    ds_read_b64_tr_b16 v[26:27], v121 offset:16896
    s_waitcnt lgkmcnt(5)
    s_add_u32 m0, s47, 98304
    v_mfma_f32_32x32x16_bf16 v[192:207], a[16:19], v[32:35], v[192:207]
    buffer_load_dwordx4 v8, s[8:11], s86 offen  lds
    ds_read_b64_tr_b16 v[28:29], v121 offset:24576
    ds_read_b64_tr_b16 v[30:31], v121 offset:25088
    s_waitcnt lgkmcnt(5)
    s_add_u32 m0, s47, 99328
    v_mfma_f32_16x16x32_bf16 v[80:83], v[112:115], v[32:35], v[80:83]
    v_mfma_f32_32x32x16_bf16 v[208:223], a[16:19], v[36:39], v[208:223]
    buffer_load_dwordx4 v9, s[8:11], s86 offen  lds
    ds_read_b128 a[24:27], v118 offset:8192
    ds_read_b64_tr_b16 v[32:33], v122 offset:16384
    ds_read_b64_tr_b16 v[34:35], v122 offset:16896
    s_waitcnt lgkmcnt(5)
    s_add_u32 m0, s47, 106496
    v_mfma_f32_16x16x32_bf16 v[148:151], v[112:115], v[36:39], v[148:151]
    v_mfma_f32_4x4x4_16b_bf16 v[88:91], a[16:17], a[16:17], v[88:91]
    v_mfma_f32_16x16x32_bf16 v[84:87], v[112:115], a[16:19], v[84:87]
    v_mfma_f32_4x4x4_16b_bf16 v[92:95], a[18:19], a[18:19], v[92:95]
    v_mfma_f32_32x32x16_bf16 v[192:207], a[20:23], v[24:27], v[192:207]
    buffer_load_dwordx4 v14, s[8:11], s86 offen  lds
    ds_read_b64_tr_b16 v[36:37], v122 offset:24576
    ds_read_b64_tr_b16 v[38:39], v122 offset:25088
    s_waitcnt lgkmcnt(5)
    s_add_u32 m0, s47, 107520
    v_mfma_f32_16x16x32_bf16 v[80:83], v[112:115], v[24:27], v[80:83]
    v_mfma_f32_32x32x16_bf16 v[208:223], a[20:23], v[28:31], v[208:223]
    buffer_load_dwordx4 v15, s[8:11], s86 offen  lds
    ds_read_b128 a[28:31], v119 offset:8192
    ds_read_b64_tr_b16 v[24:25], v123 offset:16384
    ds_read_b64_tr_b16 v[26:27], v123 offset:16896
    s_waitcnt lgkmcnt(5)
    s_add_u32 m0, s47, 114688
    v_mfma_f32_16x16x32_bf16 v[148:151], v[112:115], v[28:31], v[148:151]
    v_mfma_f32_32x32x16_bf16 v[192:207], a[24:27], v[32:35], v[192:207]
    buffer_load_dwordx4 v8, s[8:11], s87 offen  lds
    ds_read_b64_tr_b16 v[28:29], v123 offset:24576
    ds_read_b64_tr_b16 v[30:31], v123 offset:25088
    s_waitcnt lgkmcnt(5)
    s_add_u32 m0, s47, 115712
    v_mfma_f32_16x16x32_bf16 v[80:83], v[112:115], v[32:35], v[80:83]
    v_mfma_f32_32x32x16_bf16 v[208:223], a[24:27], v[36:39], v[208:223]
    buffer_load_dwordx4 v9, s[8:11], s87 offen  lds
    s_waitcnt lgkmcnt(2)
    s_add_u32 m0, s47, 122880
    v_mfma_f32_4x4x4_16b_bf16 v[88:91], a[24:25], a[24:25], v[88:91]
    v_mfma_f32_16x16x32_bf16 v[84:87], v[112:115], a[24:27], v[84:87]
    v_mfma_f32_4x4x4_16b_bf16 v[92:95], a[26:27], a[26:27], v[92:95]
    v_mfma_f32_32x32x16_bf16 v[192:207], a[28:31], v[24:27], v[192:207]
    buffer_load_dwordx4 v14, s[8:11], s87 offen  lds
    s_waitcnt lgkmcnt(0)
    s_add_u32 m0, s47, 123904
    v_mfma_f32_16x16x32_bf16 v[80:83], v[112:115], v[24:27], v[80:83]
    v_mfma_f32_32x32x16_bf16 v[208:223], a[28:31], v[28:31], v[208:223]
    buffer_load_dwordx4 v15, s[8:11], s87 offen  lds
    s_waitcnt vmcnt(24)
    v_dot2_f32_bf16 v45, v60, v22, 0
    v_dot2_f32_bf16 v23, v61, v22, 0
    v_dot2_f32_bf16 v45, v62, v22, v45
    v_dot2_f32_bf16 v23, v63, v22, v23
    s_waitcnt vmcnt(8)
    s_nop 1
    v_add_f32 v45, v45, v23
    s_barrier
    ds_read_b128 a[32:35], v116 offset:16384
    ds_read_b128 a[36:39], v117 offset:16384
    ds_read_b128 a[40:43], v118 offset:16384
    ds_read_b128 a[44:47], v119 offset:16384
    ds_read_b128 a[48:51], v116 offset:24576
    ds_read_b128 a[52:55], v117 offset:24576
    s_waitcnt lgkmcnt(5)
    s_add_u32 m0, s47, 65536
    v_mfma_f32_4x4x4_16b_bf16 v[88:91], a[32:33], a[32:33], v[88:91]
    v_mfma_f32_16x16x32_bf16 v[84:87], v[112:115], a[32:35], v[84:87]
    v_mfma_f32_4x4x4_16b_bf16 v[92:95], a[34:35], a[34:35], v[92:95]
    buffer_load_dwordx4 v8, s[8:11], s88 offen  lds
    ds_read_b128 a[56:59], v118 offset:24576
    ds_read_b128 a[60:63], v119 offset:24576
    s_waitcnt lgkmcnt(5)
    s_add_u32 m0, s47, 66560
    v_mfma_f32_4x4x4_16b_bf16 v[88:91], a[40:41], a[40:41], v[88:91]
    v_mfma_f32_16x16x32_bf16 v[84:87], v[112:115], a[40:43], v[84:87]
    v_mfma_f32_4x4x4_16b_bf16 v[92:95], a[42:43], a[42:43], v[92:95]
    buffer_load_dwordx4 v9, s[8:11], s88 offen  lds
    ds_read_b128 a[64:67], v116 offset:32768
    ds_read_b128 a[68:71], v117 offset:32768
    s_waitcnt lgkmcnt(5)
    s_add_u32 m0, s47, 73728
    v_mfma_f32_4x4x4_16b_bf16 v[88:91], a[48:49], a[48:49], v[88:91]
    v_mfma_f32_16x16x32_bf16 v[84:87], v[112:115], a[48:51], v[84:87]
    v_mfma_f32_4x4x4_16b_bf16 v[92:95], a[50:51], a[50:51], v[92:95]
    buffer_load_dwordx4 v14, s[8:11], s88 offen  lds
    ds_read_b128 a[72:75], v118 offset:32768
    ds_read_b128 a[76:79], v119 offset:32768
    s_waitcnt lgkmcnt(5)
    s_add_u32 m0, s47, 74752
    v_mfma_f32_4x4x4_16b_bf16 v[88:91], a[56:57], a[56:57], v[88:91]
    v_mfma_f32_16x16x32_bf16 v[84:87], v[112:115], a[56:59], v[84:87]
    v_mfma_f32_4x4x4_16b_bf16 v[92:95], a[58:59], a[58:59], v[92:95]
    buffer_load_dwordx4 v15, s[8:11], s88 offen  lds
    ds_read_b128 a[80:83], v116 offset:40960
    ds_read_b128 a[84:87], v117 offset:40960
    s_waitcnt lgkmcnt(5)
    s_add_u32 m0, s47, 81920
    v_mfma_f32_4x4x4_16b_bf16 v[88:91], a[64:65], a[64:65], v[88:91]
    v_mfma_f32_16x16x32_bf16 v[84:87], v[112:115], a[64:67], v[84:87]
    v_mfma_f32_4x4x4_16b_bf16 v[92:95], a[66:67], a[66:67], v[92:95]
    buffer_load_dwordx4 v8, s[8:11], s89 offen  lds
    ds_read_b128 a[88:91], v118 offset:40960
    ds_read_b128 a[92:95], v119 offset:40960
    s_waitcnt lgkmcnt(5)
    s_add_u32 m0, s47, 82944
    v_mfma_f32_4x4x4_16b_bf16 v[88:91], a[72:73], a[72:73], v[88:91]
    v_mfma_f32_16x16x32_bf16 v[84:87], v[112:115], a[72:75], v[84:87]
    v_mfma_f32_4x4x4_16b_bf16 v[92:95], a[74:75], a[74:75], v[92:95]
    buffer_load_dwordx4 v9, s[8:11], s89 offen  lds
    ds_read_b128 a[96:99], v116 offset:49152
    ds_read_b128 a[100:103], v117 offset:49152
    s_waitcnt lgkmcnt(5)
    s_add_u32 m0, s47, 90112
    v_mfma_f32_4x4x4_16b_bf16 v[88:91], a[80:81], a[80:81], v[88:91]
    v_mfma_f32_16x16x32_bf16 v[84:87], v[112:115], a[80:83], v[84:87]
    v_mfma_f32_4x4x4_16b_bf16 v[92:95], a[82:83], a[82:83], v[92:95]
    buffer_load_dwordx4 v14, s[8:11], s89 offen  lds
    ds_read_b128 a[104:107], v118 offset:49152
    ds_read_b128 a[108:111], v119 offset:49152
    s_waitcnt lgkmcnt(5)
    s_add_u32 m0, s47, 91136
    v_mfma_f32_4x4x4_16b_bf16 v[88:91], a[88:89], a[88:89], v[88:91]
    v_mfma_f32_16x16x32_bf16 v[84:87], v[112:115], a[88:91], v[84:87]
    v_mfma_f32_4x4x4_16b_bf16 v[92:95], a[90:91], a[90:91], v[92:95]
    buffer_load_dwordx4 v15, s[8:11], s89 offen  lds
    ds_read_b128 a[112:115], v116 offset:57344
    ds_read_b128 a[116:119], v117 offset:57344
    s_waitcnt lgkmcnt(5)
    v_mfma_f32_4x4x4_16b_bf16 v[88:91], a[96:97], a[96:97], v[88:91]
    v_mfma_f32_16x16x32_bf16 v[84:87], v[112:115], a[96:99], v[84:87]
    v_mfma_f32_4x4x4_16b_bf16 v[92:95], a[98:99], a[98:99], v[92:95]
    ds_read_b128 a[120:123], v118 offset:57344
    ds_read_b128 a[124:127], v119 offset:57344
    s_waitcnt lgkmcnt(5)
    v_mfma_f32_4x4x4_16b_bf16 v[88:91], a[104:105], a[104:105], v[88:91]
    v_mfma_f32_16x16x32_bf16 v[84:87], v[112:115], a[104:107], v[84:87]
    v_mfma_f32_4x4x4_16b_bf16 v[92:95], a[106:107], a[106:107], v[92:95]
    s_waitcnt lgkmcnt(3)
    v_mfma_f32_4x4x4_16b_bf16 v[88:91], a[112:113], a[112:113], v[88:91]
    v_mfma_f32_16x16x32_bf16 v[84:87], v[112:115], a[112:115], v[84:87]
    v_mfma_f32_4x4x4_16b_bf16 v[92:95], a[114:115], a[114:115], v[92:95]
    s_waitcnt lgkmcnt(1)
    v_mfma_f32_4x4x4_16b_bf16 v[88:91], a[120:121], a[120:121], v[88:91]
    v_mfma_f32_16x16x32_bf16 v[84:87], v[112:115], a[120:123], v[84:87]
    v_mfma_f32_4x4x4_16b_bf16 v[92:95], a[122:123], a[122:123], v[92:95]
    s_waitcnt vmcnt(8) lgkmcnt(0)
    s_barrier
    ds_read_b64_tr_b16 v[32:33], v120 offset:32768
    ds_read_b64_tr_b16 v[34:35], v120 offset:33280
    ds_read_b64_tr_b16 v[36:37], v120 offset:40960
    ds_read_b64_tr_b16 v[38:39], v120 offset:41472
    ds_read_b64_tr_b16 v[24:25], v121 offset:32768
    ds_read_b64_tr_b16 v[26:27], v121 offset:33280
    s_waitcnt lgkmcnt(4)
    s_add_u32 m0, s47, 0
    v_mfma_f32_32x32x16_bf16 v[192:207], a[32:35], v[32:35], v[192:207]
    buffer_load_dwordx4 v8, s[8:11], s90 offen  lds
    ds_read_b64_tr_b16 v[28:29], v121 offset:40960
    ds_read_b64_tr_b16 v[30:31], v121 offset:41472
    s_mov_b64 exec, 1
    buffer_store_dwordx2 v[4:5], v3, s[32:35], s59 offen sc1
    s_mov_b64 exec, -1
    s_waitcnt lgkmcnt(4)
    s_add_u32 m0, s47, 1024
    v_mfma_f32_16x16x32_bf16 v[80:83], v[112:115], v[32:35], v[80:83]
    v_mfma_f32_32x32x16_bf16 v[208:223], a[32:35], v[36:39], v[208:223]
    buffer_load_dwordx4 v9, s[8:11], s90 offen  lds
    ds_read_b64_tr_b16 v[32:33], v122 offset:32768
    ds_read_b64_tr_b16 v[34:35], v122 offset:33280
    ds_write_b32 v40, v84 offset:128
    s_waitcnt lgkmcnt(5)
    s_add_u32 m0, s47, 8192
    v_mfma_f32_16x16x32_bf16 v[148:151], v[112:115], v[36:39], v[148:151]
    v_mfma_f32_32x32x16_bf16 v[192:207], a[36:39], v[24:27], v[192:207]
    buffer_load_dwordx4 v14, s[8:11], s90 offen  lds
    ds_read_b64_tr_b16 v[36:37], v122 offset:40960
    ds_read_b64_tr_b16 v[38:39], v122 offset:41472
    v_add_f32 v88, v88, v92
    v_add_f32 v89, v89, v93
    s_waitcnt lgkmcnt(5)
    s_add_u32 m0, s47, 9216
    v_mfma_f32_16x16x32_bf16 v[80:83], v[112:115], v[24:27], v[80:83]
    v_mfma_f32_32x32x16_bf16 v[208:223], a[36:39], v[28:31], v[208:223]
    buffer_load_dwordx4 v15, s[8:11], s90 offen  lds
    ds_read_b64_tr_b16 v[24:25], v123 offset:32768
    ds_read_b64_tr_b16 v[26:27], v123 offset:33280
    v_add_f32 v90, v90, v94
    v_add_f32 v91, v91, v95
    s_waitcnt lgkmcnt(5)
    s_add_u32 m0, s47, 16384
    v_mfma_f32_16x16x32_bf16 v[148:151], v[112:115], v[28:31], v[148:151]
    v_mfma_f32_32x32x16_bf16 v[192:207], a[40:43], v[32:35], v[192:207]
    buffer_load_dwordx4 v8, s[8:11], s91 offen  lds
    ds_read_b64_tr_b16 v[28:29], v123 offset:40960
    ds_read_b64_tr_b16 v[30:31], v123 offset:41472
    s_mov_b32 vcc_lo, 0xaaaaaaaa
    s_mov_b32 vcc_hi, 0xaaaaaaaa
    s_waitcnt lgkmcnt(4)
    s_add_u32 m0, s47, 17408
    v_mfma_f32_16x16x32_bf16 v[80:83], v[112:115], v[32:35], v[80:83]
    v_mfma_f32_32x32x16_bf16 v[208:223], a[40:43], v[36:39], v[208:223]
    buffer_load_dwordx4 v9, s[8:11], s91 offen  lds
    ds_read_b64_tr_b16 v[32:33], v120 offset:49152
    ds_read_b64_tr_b16 v[34:35], v120 offset:49664
    v_cndmask_b32 v88, v88, v89, vcc
    v_cndmask_b32 v90, v90, v91, vcc
    s_waitcnt lgkmcnt(4)
    s_add_u32 m0, s47, 24576
    v_mfma_f32_32x32x16_bf16 v[192:207], a[44:47], v[24:27], v[192:207]
    buffer_load_dwordx4 v14, s[8:11], s91 offen  lds
    ds_read_b64_tr_b16 v[36:37], v120 offset:57344
    ds_read_b64_tr_b16 v[38:39], v120 offset:57856
    s_mov_b32 vcc_lo, 0xcccccccc
    s_mov_b32 vcc_hi, 0xcccccccc
    s_waitcnt lgkmcnt(4)
    s_add_u32 m0, s47, 25600
    v_mfma_f32_16x16x32_bf16 v[80:83], v[112:115], v[24:27], v[80:83]
    v_mfma_f32_32x32x16_bf16 v[208:223], a[44:47], v[28:31], v[208:223]
    buffer_load_dwordx4 v15, s[8:11], s91 offen  lds
    ds_read_b64_tr_b16 v[24:25], v121 offset:49152
    ds_read_b64_tr_b16 v[26:27], v121 offset:49664
    v_cndmask_b32 v88, v88, v90, vcc
    s_waitcnt lgkmcnt(4)
    v_mfma_f32_32x32x16_bf16 v[192:207], a[48:51], v[32:35], v[192:207]
    ds_read_b64_tr_b16 v[28:29], v121 offset:57344
    ds_read_b64_tr_b16 v[30:31], v121 offset:57856
    v_mov_b32 v89, v88
    s_waitcnt lgkmcnt(4)
    v_mfma_f32_16x16x32_bf16 v[80:83], v[112:115], v[32:35], v[80:83]
    v_mfma_f32_32x32x16_bf16 v[208:223], a[48:51], v[36:39], v[208:223]
    ds_read_b64_tr_b16 v[32:33], v122 offset:49152
    ds_read_b64_tr_b16 v[34:35], v122 offset:49664
    v_permlane32_swap_b32 v88, v89
    s_waitcnt lgkmcnt(4)
    v_mfma_f32_16x16x32_bf16 v[148:151], v[112:115], v[36:39], v[148:151]
    v_mfma_f32_32x32x16_bf16 v[192:207], a[52:55], v[24:27], v[192:207]
    ds_read_b64_tr_b16 v[36:37], v122 offset:57344
    ds_read_b64_tr_b16 v[38:39], v122 offset:57856
    v_add_f32 v88, v88, v89
    s_waitcnt lgkmcnt(4)
    v_mfma_f32_16x16x32_bf16 v[80:83], v[112:115], v[24:27], v[80:83]
    v_mfma_f32_32x32x16_bf16 v[208:223], a[52:55], v[28:31], v[208:223]
    ds_read_b64_tr_b16 v[24:25], v123 offset:49152
    ds_read_b64_tr_b16 v[26:27], v123 offset:49664
    ds_write_b32 v40, v88 offset:256
    s_waitcnt lgkmcnt(5)
    v_mfma_f32_16x16x32_bf16 v[148:151], v[112:115], v[28:31], v[148:151]
    v_mfma_f32_32x32x16_bf16 v[192:207], a[56:59], v[32:35], v[192:207]
    ds_read_b64_tr_b16 v[28:29], v123 offset:57344
    ds_read_b64_tr_b16 v[30:31], v123 offset:57856
    s_waitcnt lgkmcnt(5)
    v_mfma_f32_16x16x32_bf16 v[80:83], v[112:115], v[32:35], v[80:83]
    v_mfma_f32_32x32x16_bf16 v[208:223], a[56:59], v[36:39], v[208:223]
    s_waitcnt vmcnt(9) lgkmcnt(2)
    s_barrier
    ds_read_b32 v85, v42 offset:128
    ds_read_b32 v89, v42 offset:256
    ds_read_b64_tr_b16 v[32:33], v120 offset:0
    ds_read_b64_tr_b16 v[34:35], v120 offset:512
    s_waitcnt lgkmcnt(2)
    s_add_u32 m0, s47, 131072
    v_mfma_f32_32x32x16_bf16 v[192:207], a[60:63], v[24:27], v[192:207]
    buffer_load_dwordx4 v16, s[8:11], s84 offen  lds
    ds_read_b64_tr_b16 v[36:37], v120 offset:8192
    ds_read_b64_tr_b16 v[38:39], v120 offset:8704
    v_add_f32 v84, v84, v85
    v_add_f32 v88, v88, v89
    v_mfma_f32_16x16x32_bf16 v[80:83], v[112:115], v[24:27], v[80:83]
    v_mfma_f32_32x32x16_bf16 v[208:223], a[60:63], v[28:31], v[208:223]
    ds_read_b64_tr_b16 v[24:25], v121 offset:0
    ds_read_b64_tr_b16 v[26:27], v121 offset:512
    v_mul_f32 v248, 0x3b000000, v84
    v_mul_f32 v88, 0x3b000000, v88
    s_waitcnt lgkmcnt(4)
    s_add_u32 m0, s47, 132096
    v_mfma_f32_32x32x16_bf16 v[192:207], a[64:67], v[32:35], v[192:207]
    buffer_load_dwordx4 v17, s[8:11], s84 offen  lds
    ds_read_b64_tr_b16 v[28:29], v121 offset:8192
    ds_read_b64_tr_b16 v[30:31], v121 offset:8704
    v_fma_f32 v88, -v248, v248, v88
    v_max_f32 v88, 0, v88
    s_waitcnt lgkmcnt(4)
    v_mfma_f32_16x16x32_bf16 v[80:83], v[112:115], v[32:35], v[80:83]
    v_mfma_f32_32x32x16_bf16 v[208:223], a[64:67], v[36:39], v[208:223]
    ds_read_b64_tr_b16 v[32:33], v122 offset:0
    ds_read_b64_tr_b16 v[34:35], v122 offset:512
    v_cvt_pk_bf16_f32 v88, v88, v88
    v_lshlrev_b32 v88, 16, v88
    s_waitcnt lgkmcnt(4)
    s_add_u32 m0, s47, 139264
    v_mfma_f32_16x16x32_bf16 v[148:151], v[112:115], v[36:39], v[148:151]
    v_mfma_f32_32x32x16_bf16 v[192:207], a[68:71], v[24:27], v[192:207]
    buffer_load_dwordx4 v16, s[8:11], s85 offen  lds
    ds_read_b64_tr_b16 v[36:37], v122 offset:8192
    ds_read_b64_tr_b16 v[38:39], v122 offset:8704
    v_add_f32 v88, 0x3727c5ac, v88
    v_cvt_pk_bf16_f32 v88, v88, v88
    s_waitcnt lgkmcnt(4)
    v_mfma_f32_16x16x32_bf16 v[80:83], v[112:115], v[24:27], v[80:83]
    v_mfma_f32_32x32x16_bf16 v[208:223], a[68:71], v[28:31], v[208:223]
    ds_read_b64_tr_b16 v[24:25], v123 offset:0
    ds_read_b64_tr_b16 v[26:27], v123 offset:512
    v_lshlrev_b32 v88, 16, v88
    v_sqrt_f32 v88, v88
    s_waitcnt lgkmcnt(4)
    s_add_u32 m0, s47, 140288
    v_mfma_f32_16x16x32_bf16 v[148:151], v[112:115], v[28:31], v[148:151]
    v_mfma_f32_32x32x16_bf16 v[192:207], a[72:75], v[32:35], v[192:207]
    buffer_load_dwordx4 v17, s[8:11], s85 offen  lds
    ds_read_b64_tr_b16 v[28:29], v123 offset:8192
    ds_read_b64_tr_b16 v[30:31], v123 offset:8704
    v_cvt_pk_bf16_f32 v96, -v248, -v248
    v_cvt_pk_bf16_f32 v88, v88, v88
    s_waitcnt lgkmcnt(4)
    v_mfma_f32_16x16x32_bf16 v[80:83], v[112:115], v[32:35], v[80:83]
    v_mfma_f32_32x32x16_bf16 v[208:223], a[72:75], v[36:39], v[208:223]
    ds_read_b64_tr_b16 v[32:33], v120 offset:16384
    ds_read_b64_tr_b16 v[34:35], v120 offset:16896
    v_lshlrev_b32 v88, 16, v88
    v_rcp_f32 v44, v88
    s_waitcnt lgkmcnt(4)
    s_add_u32 m0, s47, 32768
    v_mfma_f32_32x32x16_bf16 v[192:207], a[76:79], v[24:27], v[192:207]
    buffer_load_dwordx4 v16, s[8:11], s86 offen  lds
    ds_read_b64_tr_b16 v[36:37], v120 offset:24576
    ds_read_b64_tr_b16 v[38:39], v120 offset:25088
    v_cndmask_b32 v96, 0, v96, s[64:65]
    ds_write_b32 v40, v44 offset:384
    s_waitcnt lgkmcnt(5)
    v_mfma_f32_16x16x32_bf16 v[80:83], v[112:115], v[24:27], v[80:83]
    v_mfma_f32_32x32x16_bf16 v[208:223], a[76:79], v[28:31], v[208:223]
    ds_read_b64_tr_b16 v[24:25], v121 offset:16384
    ds_read_b64_tr_b16 v[26:27], v121 offset:16896
    ds_read_b128 v[64:67], v43 offset:384
    s_waitcnt lgkmcnt(6)
    s_add_u32 m0, s47, 33792
    v_mfma_f32_32x32x16_bf16 v[192:207], a[80:83], v[32:35], v[192:207]
    buffer_load_dwordx4 v17, s[8:11], s86 offen  lds
    ds_read_b64_tr_b16 v[28:29], v121 offset:24576
    ds_read_b64_tr_b16 v[30:31], v121 offset:25088
    buffer_load_dwordx2 v[60:61], v180, s[32:35], s56 offen sc1
    buffer_load_dwordx4 v[56:59], v181, s[32:35], s57 offen sc1
    ds_read_b128 v[68:71], v43 offset:416
    s_waitcnt lgkmcnt(7)
    v_mfma_f32_16x16x32_bf16 v[80:83], v[112:115], v[32:35], v[80:83]
    v_mfma_f32_32x32x16_bf16 v[208:223], a[80:83], v[36:39], v[208:223]
    ds_read_b64_tr_b16 v[32:33], v122 offset:16384
    ds_read_b64_tr_b16 v[34:35], v122 offset:16896
    ds_read_b128 v[72:75], v43 offset:448
    s_waitcnt lgkmcnt(7)
    s_add_u32 m0, s47, 40960
    v_mfma_f32_16x16x32_bf16 v[148:151], v[112:115], v[36:39], v[148:151]
    v_mfma_f32_32x32x16_bf16 v[192:207], a[84:87], v[24:27], v[192:207]
    buffer_load_dwordx4 v16, s[8:11], s87 offen  lds
    ds_read_b64_tr_b16 v[36:37], v122 offset:24576
    ds_read_b64_tr_b16 v[38:39], v122 offset:25088
    ds_read_b128 v[76:79], v43 offset:480
    s_waitcnt lgkmcnt(7)
    v_mfma_f32_16x16x32_bf16 v[80:83], v[112:115], v[24:27], v[80:83]
    v_mfma_f32_32x32x16_bf16 v[208:223], a[84:87], v[28:31], v[208:223]
    ds_read_b64_tr_b16 v[24:25], v123 offset:16384
    ds_read_b64_tr_b16 v[26:27], v123 offset:16896
    v_add_f32_dpp v45, v45, v45 row_ror:8 row_mask:0xf bank_mask:0xf
    s_waitcnt lgkmcnt(6)
    s_add_u32 m0, s47, 41984
    v_mfma_f32_16x16x32_bf16 v[148:151], v[112:115], v[28:31], v[148:151]
    v_mfma_f32_32x32x16_bf16 v[192:207], a[88:91], v[32:35], v[192:207]
    buffer_load_dwordx4 v17, s[8:11], s87 offen  lds
    ds_read_b64_tr_b16 v[28:29], v123 offset:24576
    ds_read_b64_tr_b16 v[30:31], v123 offset:25088
    v_add_f32_dpp v45, v45, v45 row_ror:4 row_mask:0xf bank_mask:0xf
    s_waitcnt lgkmcnt(5)
    v_mfma_f32_16x16x32_bf16 v[80:83], v[112:115], v[32:35], v[80:83]
    v_mfma_f32_32x32x16_bf16 v[208:223], a[88:91], v[36:39], v[208:223]
    s_waitcnt vmcnt(14)
    s_barrier
    ds_read_b64_tr_b16 v[32:33], v124 offset:0
    ds_read_b64_tr_b16 v[34:35], v124 offset:512
    v_add_f32_dpp v45, v45, v45 row_ror:2 row_mask:0xf bank_mask:0xf
    s_waitcnt lgkmcnt(4)
    s_add_u32 m0, s47, 49152
    v_mfma_f32_32x32x16_bf16 v[192:207], a[92:95], v[24:27], v[192:207]
    buffer_load_dwordx4 v16, s[8:11], s88 offen  lds
    ds_read_b64_tr_b16 v[36:37], v124 offset:8192
    ds_read_b64_tr_b16 v[38:39], v124 offset:8704
    v_add_f32_dpp v45, v45, v45 row_ror:1 row_mask:0xf bank_mask:0xf
    s_waitcnt lgkmcnt(4)
    v_mfma_f32_16x16x32_bf16 v[80:83], v[112:115], v[24:27], v[80:83]
    v_mfma_f32_32x32x16_bf16 v[208:223], a[92:95], v[28:31], v[208:223]
    ds_read_b64_tr_b16 v[24:25], v125 offset:0
    ds_read_b64_tr_b16 v[26:27], v125 offset:512
    v_mov_b32 v23, v45
    s_waitcnt lgkmcnt(4)
    s_add_u32 m0, s47, 50176
    v_mfma_f32_32x32x16_bf16 v[192:207], a[96:99], v[32:35], v[192:207]
    buffer_load_dwordx4 v17, s[8:11], s88 offen  lds
    ds_read_b64_tr_b16 v[28:29], v125 offset:8192
    ds_read_b64_tr_b16 v[30:31], v125 offset:8704
    v_permlane16_swap_b32 v45, v23
    s_waitcnt lgkmcnt(4)
    v_mfma_f32_16x16x32_bf16 v[80:83], v[112:115], v[32:35], v[80:83]
    v_mfma_f32_32x32x16_bf16 v[208:223], a[96:99], v[36:39], v[208:223]
    ds_read_b64_tr_b16 v[32:33], v126 offset:0
    ds_read_b64_tr_b16 v[34:35], v126 offset:512
    v_add_f32 v45, v45, v23
    v_mov_b32 v23, v45
    s_waitcnt lgkmcnt(4)
    s_add_u32 m0, s47, 57344
    v_mfma_f32_16x16x32_bf16 v[148:151], v[112:115], v[36:39], v[148:151]
    v_mfma_f32_32x32x16_bf16 v[192:207], a[100:103], v[24:27], v[192:207]
    buffer_load_dwordx4 v16, s[8:11], s89 offen  lds
    ds_read_b64_tr_b16 v[36:37], v126 offset:8192
    ds_read_b64_tr_b16 v[38:39], v126 offset:8704
    v_permlane32_swap_b32 v45, v23
    s_waitcnt lgkmcnt(4)
    v_mfma_f32_16x16x32_bf16 v[80:83], v[112:115], v[24:27], v[80:83]
    v_mfma_f32_32x32x16_bf16 v[208:223], a[100:103], v[28:31], v[208:223]
    ds_read_b64_tr_b16 v[24:25], v127 offset:0
    ds_read_b64_tr_b16 v[26:27], v127 offset:512
    v_add_f32 v45, v45, v23
    v_mul_f32 v45, 0x3b000000, v45
    s_waitcnt lgkmcnt(4)
    s_add_u32 m0, s47, 58368
    v_mfma_f32_16x16x32_bf16 v[148:151], v[112:115], v[28:31], v[148:151]
    v_mfma_f32_32x32x16_bf16 v[192:207], a[104:107], v[32:35], v[192:207]
    buffer_load_dwordx4 v17, s[8:11], s89 offen  lds
    ds_read_b64_tr_b16 v[28:29], v127 offset:8192
    ds_read_b64_tr_b16 v[30:31], v127 offset:8704
    v_cndmask_b32 v45, 0, v45, s[62:63]
    s_waitcnt lgkmcnt(4)
    v_mfma_f32_16x16x32_bf16 v[80:83], v[112:115], v[32:35], v[80:83]
    v_mfma_f32_32x32x16_bf16 v[208:223], a[104:107], v[36:39], v[208:223]
    s_waitcnt vmcnt(14)
    s_barrier
    ds_read_b64_tr_b16 v[32:33], v124 offset:16384
    ds_read_b64_tr_b16 v[34:35], v124 offset:16896
    s_waitcnt vmcnt(6)
    s_mov_b32 s68, 0
zp_1:
    v_cmp_ne_u64 s[66:67], v[60:61], v[4:5]
    v_cmp_ne_u64 s[62:63], v[56:57], v[4:5]
    s_nop 0
    s_or_b64 s[66:67], s[66:67], s[62:63]
    s_cbranch_scc0 zo_2
    s_add_u32 s68, s68, 1
    s_cmp_gt_u32 s68, 400000
    s_cbranch_scc1 L_end
    buffer_load_dwordx2 v[60:61], v180, s[32:35], s56 offen sc1
    buffer_load_dwordx4 v[56:59], v181, s[32:35], s57 offen sc1
    s_waitcnt vmcnt(0)
    s_branch zp_1
zo_2:
    v_cmp_ne_u32 s[62:63], s38, v58
    s_waitcnt lgkmcnt(4)
    s_add_u32 m0, s47, 147456
    v_mfma_f32_32x32x16_bf16 v[192:207], a[108:111], v[24:27], v[192:207]
    buffer_load_dwordx4 v46, s[4:7], s60 offen  lds
    ds_read_b64_tr_b16 v[36:37], v124 offset:24576
    ds_read_b64_tr_b16 v[38:39], v124 offset:25088
    s_waitcnt lgkmcnt(4)
    v_mfma_f32_16x16x32_bf16 v[80:83], v[112:115], v[24:27], v[80:83]
    v_mfma_f32_32x32x16_bf16 v[208:223], a[108:111], v[28:31], v[208:223]
    ds_read_b64_tr_b16 v[24:25], v125 offset:16384
    ds_read_b64_tr_b16 v[26:27], v125 offset:16896
    s_waitcnt lgkmcnt(4)
    s_add_u32 m0, s47, 148480
    v_mfma_f32_32x32x16_bf16 v[192:207], a[112:115], v[32:35], v[192:207]
    buffer_load_dwordx4 v47, s[4:7], s60 offen  lds
    ds_read_b64_tr_b16 v[28:29], v125 offset:24576
    ds_read_b64_tr_b16 v[30:31], v125 offset:25088
    s_waitcnt lgkmcnt(4)
    v_mfma_f32_16x16x32_bf16 v[80:83], v[112:115], v[32:35], v[80:83]
    v_mfma_f32_32x32x16_bf16 v[208:223], a[112:115], v[36:39], v[208:223]
    ds_read_b64_tr_b16 v[32:33], v126 offset:16384
    ds_read_b64_tr_b16 v[34:35], v126 offset:16896
    s_waitcnt lgkmcnt(4)
    s_add_u32 m0, s47, 65536
    v_mfma_f32_16x16x32_bf16 v[148:151], v[112:115], v[36:39], v[148:151]
    v_mfma_f32_32x32x16_bf16 v[192:207], a[116:119], v[24:27], v[192:207]
    buffer_load_dwordx4 v16, s[8:11], s90 offen  lds
    ds_read_b64_tr_b16 v[36:37], v126 offset:24576
    ds_read_b64_tr_b16 v[38:39], v126 offset:25088
    s_waitcnt lgkmcnt(4)
    s_add_u32 m0, s47, 66560
    v_mfma_f32_16x16x32_bf16 v[80:83], v[112:115], v[24:27], v[80:83]
    v_mfma_f32_32x32x16_bf16 v[208:223], a[116:119], v[28:31], v[208:223]
    buffer_load_dwordx4 v17, s[8:11], s90 offen  lds
    ds_read_b64_tr_b16 v[24:25], v127 offset:16384
    ds_read_b64_tr_b16 v[26:27], v127 offset:16896
    s_waitcnt lgkmcnt(4)
    s_add_u32 m0, s47, 73728
    v_mfma_f32_16x16x32_bf16 v[148:151], v[112:115], v[28:31], v[148:151]
    v_mfma_f32_32x32x16_bf16 v[192:207], a[120:123], v[32:35], v[192:207]
    buffer_load_dwordx4 v16, s[8:11], s91 offen  lds
    ds_read_b64_tr_b16 v[28:29], v127 offset:24576
    ds_read_b64_tr_b16 v[30:31], v127 offset:25088
    s_waitcnt lgkmcnt(4)
    s_add_u32 m0, s47, 74752
    v_mfma_f32_16x16x32_bf16 v[80:83], v[112:115], v[32:35], v[80:83]
    v_mfma_f32_32x32x16_bf16 v[208:223], a[120:123], v[36:39], v[208:223]
    buffer_load_dwordx4 v17, s[8:11], s91 offen  lds
    s_waitcnt lgkmcnt(2)
    s_add_u32 m0, s3, 98304
    v_mfma_f32_32x32x16_bf16 v[192:207], a[124:127], v[24:27], v[192:207]
    buffer_load_dwordx4 v12, s[16:19], s49 offen nt lds
    s_waitcnt lgkmcnt(0)
    s_add_u32 m0, s3, 99328
    v_mfma_f32_16x16x32_bf16 v[80:83], v[112:115], v[24:27], v[80:83]
    v_mfma_f32_32x32x16_bf16 v[208:223], a[124:127], v[28:31], v[208:223]
    buffer_load_dwordx4 v12, s[16:19], s50 offen nt lds
    ds_write_b32 v40, v148
    s_nop 4
    v_cvt_pk_bf16_f32 v23, v80, v80
    v_lshlrev_b32 v23, 16, v23
    v_sub_f32 v80, v80, v23
    v_cvt_pk_bf16_f32 v100, v23, v80
    s_nop 1
    v_mfma_f32_32x32x16_bf16 v[192:207], v[96:99], v[100:103], v[192:207]
    s_waitcnt lgkmcnt(0)
    s_barrier
    ds_read_b32 v149, v41
    s_mov_b32 vcc_lo, 0xffff0000
    s_mov_b32 vcc_hi, 0xffff0000
    s_nop 6
    v_pk_mul_f32 v[192:193], v[192:193], v[64:65]
    v_pk_mul_f32 v[194:195], v[194:195], v[66:67]
    v_pk_mul_f32 v[196:197], v[196:197], v[68:69]
    v_pk_mul_f32 v[198:199], v[198:199], v[70:71]
    v_pk_mul_f32 v[200:201], v[200:201], v[72:73]
    v_pk_mul_f32 v[202:203], v[202:203], v[74:75]
    v_pk_mul_f32 v[204:205], v[204:205], v[76:77]
    v_pk_mul_f32 v[206:207], v[206:207], v[78:79]
    s_waitcnt lgkmcnt(0)
    v_add_f32 v148, v148, v149
    v_cvt_pk_bf16_f32 v23, v148, v148
    v_lshlrev_b32 v23, 16, v23
    s_add_u32 m0, s3, 100352
    v_sub_f32 v148, v148, v23
    buffer_load_dwordx4 v12, s[20:23], s49 offen nt lds
    v_cvt_pk_bf16_f32 v104, v23, v148
    s_nop 1
    v_mfma_f32_32x32x16_bf16 v[208:223], v[96:99], v[104:107], v[208:223]
    v_pk_mul_f32 v[160:161], v[192:193], v[182:183] op_sel_hi:[1,0]
    v_pk_mul_f32 v[162:163], v[194:195], v[182:183] op_sel_hi:[1,0]
    v_pk_mul_f32 v[164:165], v[196:197], v[182:183] op_sel_hi:[1,0]
    v_pk_mul_f32 v[166:167], v[198:199], v[182:183] op_sel_hi:[1,0]
    v_pk_mul_f32 v[168:169], v[200:201], v[182:183] op_sel_hi:[1,0]
    v_pk_mul_f32 v[170:171], v[202:203], v[182:183] op_sel_hi:[1,0]
    v_pk_mul_f32 v[172:173], v[204:205], v[182:183] op_sel_hi:[1,0]
    v_pk_mul_f32 v[174:175], v[206:207], v[182:183] op_sel_hi:[1,0]
    v_exp_f32_e64 v160, v160 clamp
    s_add_u32 m0, s3, 101376
    v_max_f32 v192, 0, v192
    buffer_load_dwordx4 v12, s[20:23], s50 offen nt lds
    v_exp_f32_e64 v161, v161 clamp
    v_max_f32 v193, 0, v193
    v_exp_f32_e64 v162, v162 clamp
    v_max_f32 v194, 0, v194
    v_exp_f32_e64 v163, v163 clamp
    v_max_f32 v195, 0, v195
    v_exp_f32_e64 v164, v164 clamp
    v_max_f32 v196, 0, v196
    v_exp_f32_e64 v165, v165 clamp
    v_max_f32 v197, 0, v197
    v_exp_f32_e64 v166, v166 clamp
    s_add_u32 m0, s3, 102400
    v_max_f32 v198, 0, v198
    buffer_load_dwordx4 v11, s[24:27], s52 offen nt lds
    v_exp_f32_e64 v167, v167 clamp
    v_max_f32 v199, 0, v199
    v_exp_f32_e64 v168, v168 clamp
    v_max_f32 v200, 0, v200
    v_exp_f32_e64 v169, v169 clamp
    v_max_f32 v201, 0, v201
    v_exp_f32_e64 v170, v170 clamp
    v_max_f32 v202, 0, v202
    v_exp_f32_e64 v171, v171 clamp
    v_max_f32 v203, 0, v203
    v_exp_f32_e64 v172, v172 clamp
    s_add_u32 m0, s3, 103424
    v_max_f32 v204, 0, v204
    buffer_load_dwordx4 v11, s[24:27], s53 offen nt lds
    v_exp_f32_e64 v173, v173 clamp
    v_max_f32 v205, 0, v205
    v_exp_f32_e64 v174, v174 clamp
    v_max_f32 v206, 0, v206
    v_exp_f32_e64 v175, v175 clamp
    v_max_f32 v207, 0, v207
    v_pk_add_f32 v[192:193], v[192:193], v[182:183] op_sel:[0,1] op_sel_hi:[1,1]
    v_pk_add_f32 v[194:195], v[194:195], v[182:183] op_sel:[0,1] op_sel_hi:[1,1]
    v_pk_add_f32 v[196:197], v[196:197], v[182:183] op_sel:[0,1] op_sel_hi:[1,1]
    v_pk_add_f32 v[198:199], v[198:199], v[182:183] op_sel:[0,1] op_sel_hi:[1,1]
    v_pk_add_f32 v[200:201], v[200:201], v[182:183] op_sel:[0,1] op_sel_hi:[1,1]
    v_pk_add_f32 v[202:203], v[202:203], v[182:183] op_sel:[0,1] op_sel_hi:[1,1]
    v_pk_add_f32 v[204:205], v[204:205], v[182:183] op_sel:[0,1] op_sel_hi:[1,1]
    v_pk_add_f32 v[206:207], v[206:207], v[182:183] op_sel:[0,1] op_sel_hi:[1,1]
    v_pk_add_f32 v[160:161], v[160:161], v[192:193]
    v_pk_add_f32 v[162:163], v[162:163], v[194:195]
    v_pk_add_f32 v[164:165], v[164:165], v[196:197]
    v_pk_add_f32 v[166:167], v[166:167], v[198:199]
    v_pk_add_f32 v[168:169], v[168:169], v[200:201]
    v_pk_add_f32 v[170:171], v[170:171], v[202:203]
    v_pk_add_f32 v[172:173], v[172:173], v[204:205]
    v_pk_add_f32 v[174:175], v[174:175], v[206:207]
    v_cvt_pk_bf16_f32 v48, v160, v161
    v_cvt_pk_bf16_f32 v49, v162, v163
    v_cvt_pk_bf16_f32 v50, v164, v165
    v_cvt_pk_bf16_f32 v51, v166, v167
    v_cvt_pk_bf16_f32 v52, v168, v169
    v_cvt_pk_bf16_f32 v53, v170, v171
    v_cvt_pk_bf16_f32 v54, v172, v173
    v_cvt_pk_bf16_f32 v55, v174, v175
    v_mfma_f32_32x32x16_bf16 v[224:239], v[188:191], v[48:51], 0
    v_mul_f32 v208, v208, v64
    v_mul_f32 v209, v209, v65
    v_mul_f32 v210, v210, v66
    v_mul_f32 v211, v211, v67
    v_mul_f32 v212, v212, v68
    v_mul_f32 v213, v213, v69
    v_mul_f32 v214, v214, v70
    v_mul_f32 v215, v215, v71
    v_mfma_f32_32x32x16_bf16 v[224:239], v[188:191], v[52:55], v[224:239]
    v_cvt_pk_bf16_f32 v32, v208, v209
    v_cvt_pk_bf16_f32 v33, v210, v211
    v_cvt_pk_bf16_f32 v34, v212, v213
    v_cvt_pk_bf16_f32 v35, v214, v215
    v_mul_f32 v216, v216, v72
    v_mul_f32 v217, v217, v73
    v_mul_f32 v218, v218, v74
    v_mul_f32 v219, v219, v75
    v_mfma_f32_32x32x16_bf16 v[160:175], v[48:51], v[32:35], 0
    v_mul_f32 v220, v220, v76
    v_mul_f32 v221, v221, v77
    v_mul_f32 v222, v222, v78
    v_mul_f32 v223, v223, v79
    v_cvt_pk_bf16_f32 v36, v216, v217
    v_cvt_pk_bf16_f32 v37, v218, v219
    v_cvt_pk_bf16_f32 v38, v220, v221
    v_cvt_pk_bf16_f32 v39, v222, v223
    s_nop 1
    v_mfma_f32_32x32x16_bf16 v[160:175], v[52:55], v[36:39], v[160:175]
    s_cmp_eq_u64 s[62:63], 0
    s_cselect_b32 s52, 0, 0x7f000000
    s_cselect_b32 s53, 0x7f000000, 0
    v_mov_b32 v249, 0x7f000000
    v_mov_b32 v250, 0x7f000000
    v_writelane_b32 v249, s52, 0
    v_writelane_b32 v250, s53, 0
    s_nop 4
    v_cndmask_b32 v128, v160, v168, vcc
    v_cndmask_b32 v129, v161, v169, vcc
    v_cndmask_b32 v130, v162, v170, vcc
    v_cndmask_b32 v132, v163, v171, vcc
    v_cndmask_b32 v133, v164, v172, vcc
    v_cndmask_b32 v134, v165, v173, vcc
    v_cndmask_b32 v136, v166, v174, vcc
    v_cndmask_b32 v137, v167, v175, vcc
    ds_write_b128 v176, v[128:131] offset:0
    ds_write_b128 v176, v[132:135] offset:1024
    ds_write_b128 v176, v[136:139] offset:2048
    v_cndmask_b32 v45, v45, v224, s[64:65]
    ds_write_b32 v177, v45 offset:2056
    v_add_u32 v116, 131072, v124
    v_add_u32 v117, 131072, v125
    v_add_u32 v118, 131072, v126
    v_add_u32 v119, 131072, v127
    s_waitcnt lgkmcnt(0)
    s_barrier
    ds_read2st64_b32 v[128:129], v179 offset0:0 offset1:24
    ds_read2st64_b32 v[130:131], v179 offset0:1 offset1:25
    ds_read2st64_b32 v[132:133], v179 offset0:2 offset1:26
    ds_read2st64_b32 v[134:135], v179 offset0:3 offset1:27
    ds_read2st64_b32 v[136:137], v179 offset0:4 offset1:28
    ds_read2st64_b32 v[138:139], v179 offset0:5 offset1:29
    ds_read_b64_tr_b16 v[32:33], v116 offset:0
    ds_read_b64_tr_b16 v[34:35], v116 offset:512
    ds_read_b64_tr_b16 v[36:37], v117 offset:0
    ds_read_b64_tr_b16 v[38:39], v117 offset:512
    ds_read_b64_tr_b16 v[24:25], v118 offset:0
    ds_read_b64_tr_b16 v[26:27], v118 offset:512
    s_waitcnt lgkmcnt(6)
    v_add_f32 v128, v128, v129
    v_add_f32 v130, v130, v131
    buffer_atomic_add_f32 v128, v178, s[32:35], s55 offen offset:0
    v_add_f32 v132, v132, v133
    buffer_atomic_add_f32 v130, v178, s[32:35], s55 offen offset:256
    v_add_f32 v134, v134, v135
    buffer_atomic_add_f32 v132, v178, s[32:35], s55 offen offset:512
    v_add_f32 v136, v136, v137
    buffer_atomic_add_f32 v134, v178, s[32:35], s55 offen offset:768
    v_add_f32 v138, v138, v139
    buffer_atomic_add_f32 v136, v178, s[32:35], s55 offen offset:1024
    buffer_atomic_add_f32 v138, v178, s[32:35], s55 offen offset:1280
    s_waitcnt lgkmcnt(4)
    v_mfma_f32_32x32x16_bf16 v[224:239], v[32:35], a[0:3], 0
    ds_read_b64_tr_b16 v[28:29], v119 offset:0
    ds_read_b64_tr_b16 v[30:31], v119 offset:512
    s_lshl_b32 s52, s39, 1
    s_add_u32 s61, s52, s46
    s_mul_i32 s52, s61, 3072
    v_mfma_f32_16x16x32_bf16 v[80:83], v[112:115], v[32:35], 0
    s_waitcnt lgkmcnt(4)
    v_mfma_f32_32x32x16_bf16 v[224:239], v[36:39], a[4:7], v[224:239]
    ds_read_b64_tr_b16 v[32:33], v116 offset:8192
    ds_read_b64_tr_b16 v[34:35], v116 offset:8704
    s_add_u32 s52, s52, 262144
    s_add_u32 s53, s52, 49152
    s_lshl_b32 s60, s41, 1
    v_mfma_f32_16x16x32_bf16 v[80:83], v[112:115], v[36:39], v[80:83]
    s_waitcnt lgkmcnt(4)
    v_mfma_f32_32x32x16_bf16 v[224:239], v[24:27], a[8:11], v[224:239]
    ds_read_b64_tr_b16 v[36:37], v117 offset:8192
    ds_read_b64_tr_b16 v[38:39], v117 offset:8704
    s_add_u32 s60, s60, s45
    s_mul_i32 s60, s60, 33792
    s_add_u32 s60, s60, 1048576
    s_lshl_b32 s62, s61, 11
    s_waitcnt lgkmcnt(4)
    v_mfma_f32_32x32x16_bf16 v[224:239], v[28:31], a[12:15], v[224:239]
    ds_read_b64_tr_b16 v[24:25], v118 offset:8192
    ds_read_b64_tr_b16 v[26:27], v118 offset:8704
    s_add_u32 s62, s62, s60
    s_lshl_b32 s63, s61, 6
    s_add_u32 s63, s63, s60
    s_add_u32 s63, s63, 32768
    s_waitcnt lgkmcnt(4)
    v_mfma_f32_32x32x16_bf16 v[224:239], v[32:35], a[16:19], v[224:239]
    ds_read_b64_tr_b16 v[28:29], v119 offset:8192
    ds_read_b64_tr_b16 v[30:31], v119 offset:8704
    v_lshlrev_b32 v47, 1, v1
    s_lshl_b32 s64, s41, 3
    s_add_u32 s64, s64, s39
    v_mfma_f32_16x16x32_bf16 v[80:83], v[112:115], v[32:35], v[80:83]
    s_waitcnt lgkmcnt(4)
    v_mfma_f32_32x32x16_bf16 v[224:239], v[36:39], a[20:23], v[224:239]
    s_waitcnt vmcnt(12)
    s_barrier
    ds_read_b64_tr_b16 v[32:33], v124 offset:32768
    ds_read_b64_tr_b16 v[34:35], v124 offset:33280
    s_lshl_b32 s64, s64, 3
    s_add_u32 s64, s64, 8192
    s_cmp_eq_u32 s36, 0
    v_mfma_f32_16x16x32_bf16 v[80:83], v[112:115], v[36:39], v[80:83]
    s_waitcnt lgkmcnt(4)
    v_mfma_f32_32x32x16_bf16 v[224:239], v[24:27], a[24:27], v[224:239]
    ds_read_b64_tr_b16 v[36:37], v125 offset:32768
    ds_read_b64_tr_b16 v[38:39], v125 offset:33280
    s_cselect_b32 s64, s64, 0x7f000000
    s_lshl_b32 s65, s39, 5
    s_add_u32 s65, s65, s41
    s_lshl_b32 s65, s65, 6
    s_waitcnt lgkmcnt(4)
    v_mfma_f32_32x32x16_bf16 v[224:239], v[28:31], a[28:31], v[224:239]
    ds_read_b64_tr_b16 v[24:25], v126 offset:32768
    ds_read_b64_tr_b16 v[26:27], v126 offset:33280
    s_add_u32 s65, s65, 131072
    s_cmp_eq_u32 s36, 0
    s_cselect_b32 s65, s65, 0x7f000000
    s_lshl_b32 s84, s36, 16
    s_waitcnt lgkmcnt(4)
    v_mfma_f32_32x32x16_bf16 v[224:239], v[32:35], a[32:35], v[224:239]
    ds_read_b64_tr_b16 v[28:29], v127 offset:32768
    ds_read_b64_tr_b16 v[30:31], v127 offset:33280
    s_lshl_b32 s85, s39, 7
    s_add_u32 s84, s84, s85
    v_add_u32 v46, s84, v11
    v_mfma_f32_16x16x32_bf16 v[80:83], v[112:115], v[32:35], v[80:83]
    s_waitcnt lgkmcnt(4)
    v_mfma_f32_32x32x16_bf16 v[224:239], v[36:39], a[36:39], v[224:239]
    ds_read_b64_tr_b16 v[32:33], v124 offset:40960
    ds_read_b64_tr_b16 v[34:35], v124 offset:41472
    s_lshl_b32 s85, s36, 13
    s_add_u32 s66, s40, 0
    s_and_b32 s66, s66, 3
    v_mfma_f32_16x16x32_bf16 v[80:83], v[112:115], v[36:39], v[80:83]
    s_waitcnt lgkmcnt(4)
    v_mfma_f32_32x32x16_bf16 v[224:239], v[24:27], a[40:43], v[224:239]
    ds_read_b64_tr_b16 v[36:37], v125 offset:40960
    ds_read_b64_tr_b16 v[38:39], v125 offset:41472
    s_lshl_b32 s92, s66, 14
    s_lshl_b32 s66, s66, 11
    s_add_u32 s96, s66, s85
    s_add_u32 s66, s40, 1
    s_waitcnt lgkmcnt(4)
    v_mfma_f32_32x32x16_bf16 v[224:239], v[28:31], a[44:47], v[224:239]
    ds_read_b64_tr_b16 v[24:25], v126 offset:40960
    ds_read_b64_tr_b16 v[26:27], v126 offset:41472
    s_and_b32 s66, s66, 3
    s_lshl_b32 s93, s66, 14
    s_lshl_b32 s66, s66, 11
    s_add_u32 s97, s66, s85
    s_waitcnt lgkmcnt(4)
    v_mfma_f32_32x32x16_bf16 v[224:239], v[32:35], a[48:51], v[224:239]
    ds_read_b64_tr_b16 v[28:29], v127 offset:40960
    ds_read_b64_tr_b16 v[30:31], v127 offset:41472
    s_add_u32 s66, s40, 2
    s_and_b32 s66, s66, 3
    s_lshl_b32 s94, s66, 14
    v_mfma_f32_16x16x32_bf16 v[80:83], v[112:115], v[32:35], v[80:83]
    s_waitcnt lgkmcnt(4)
    v_mfma_f32_32x32x16_bf16 v[224:239], v[36:39], a[52:55], v[224:239]
    ds_read_b64_tr_b16 v[32:33], v124 offset:49152
    ds_read_b64_tr_b16 v[34:35], v124 offset:49664
    s_lshl_b32 s66, s66, 11
    s_add_u32 s54, s66, s85
    s_add_u32 s66, s40, 3
    v_mfma_f32_16x16x32_bf16 v[80:83], v[112:115], v[36:39], v[80:83]
    s_waitcnt lgkmcnt(4)
    v_mfma_f32_32x32x16_bf16 v[224:239], v[24:27], a[56:59], v[224:239]
    ds_read_b64_tr_b16 v[36:37], v125 offset:49152
    ds_read_b64_tr_b16 v[38:39], v125 offset:49664
    s_and_b32 s66, s66, 3
    s_lshl_b32 s95, s66, 14
    s_lshl_b32 s66, s66, 11
    s_add_u32 s55, s66, s85
    s_waitcnt lgkmcnt(4)
    v_mfma_f32_32x32x16_bf16 v[224:239], v[28:31], a[60:63], v[224:239]
    ds_read_b64_tr_b16 v[24:25], v126 offset:49152
    ds_read_b64_tr_b16 v[26:27], v126 offset:49664
    ds_read_b64 v[240:241], v10
    v_xor_b32 v23, 16, v10
    ds_read_b64 v[242:243], v23
    v_xor_b32 v23, 32, v10
    s_waitcnt lgkmcnt(6)
    v_mfma_f32_32x32x16_bf16 v[224:239], v[32:35], a[64:67], v[224:239]
    ds_read_b64_tr_b16 v[28:29], v127 offset:49152
    ds_read_b64_tr_b16 v[30:31], v127 offset:49664
    ds_read_b64 v[244:245], v23
    v_xor_b32 v23, 48, v10
    ds_read_b64 v[246:247], v23
    v_mfma_f32_16x16x32_bf16 v[80:83], v[112:115], v[32:35], v[80:83]
    s_waitcnt lgkmcnt(8)
    v_mfma_f32_32x32x16_bf16 v[224:239], v[36:39], a[68:71], v[224:239]
    ds_read_b64_tr_b16 v[32:33], v124 offset:57344
    ds_read_b64_tr_b16 v[34:35], v124 offset:57856
    s_add_u32 m0, s96, 0
    s_add_u32 s66, s92, 0
    buffer_load_dwordx4 v46, s[12:15], s66 offen  lds
    v_mfma_f32_16x16x32_bf16 v[80:83], v[112:115], v[36:39], v[80:83]
    s_waitcnt lgkmcnt(8)
    v_mfma_f32_32x32x16_bf16 v[224:239], v[24:27], a[72:75], v[224:239]
    ds_read_b64_tr_b16 v[36:37], v125 offset:57344
    ds_read_b64_tr_b16 v[38:39], v125 offset:57856
    s_add_u32 m0, s96, 1024
    s_add_u32 s66, s92, 8192
    buffer_load_dwordx4 v46, s[12:15], s66 offen  lds
    s_waitcnt lgkmcnt(6)
    v_mfma_f32_32x32x16_bf16 v[224:239], v[28:31], a[76:79], v[224:239]
    ds_read_b64_tr_b16 v[24:25], v126 offset:57344
    ds_read_b64_tr_b16 v[26:27], v126 offset:57856
    s_add_u32 m0, s97, 0
    s_add_u32 s66, s93, 0
    buffer_load_dwordx4 v46, s[12:15], s66 offen  lds
    s_waitcnt lgkmcnt(4)
    v_mfma_f32_32x32x16_bf16 v[224:239], v[32:35], a[80:83], v[224:239]
    ds_read_b64_tr_b16 v[28:29], v127 offset:57344
    ds_read_b64_tr_b16 v[30:31], v127 offset:57856
    s_add_u32 m0, s97, 1024
    s_add_u32 s66, s93, 8192
    buffer_load_dwordx4 v46, s[12:15], s66 offen  lds
    v_mfma_f32_16x16x32_bf16 v[80:83], v[112:115], v[32:35], v[80:83]
    s_waitcnt lgkmcnt(4)
    v_mfma_f32_32x32x16_bf16 v[224:239], v[36:39], a[84:87], v[224:239]
    ds_read_b64_tr_b16 v[32:33], v120 offset:0
    ds_read_b64_tr_b16 v[34:35], v120 offset:512
    s_add_u32 m0, s54, 0
    s_add_u32 s66, s94, 0
    buffer_load_dwordx4 v46, s[12:15], s66 offen  lds
    v_mfma_f32_16x16x32_bf16 v[80:83], v[112:115], v[36:39], v[80:83]
    s_waitcnt lgkmcnt(4)
    v_mfma_f32_32x32x16_bf16 v[224:239], v[24:27], a[88:91], v[224:239]
    ds_read_b64_tr_b16 v[36:37], v121 offset:0
    ds_read_b64_tr_b16 v[38:39], v121 offset:512
    s_add_u32 m0, s54, 1024
    s_add_u32 s66, s94, 8192
    buffer_load_dwordx4 v46, s[12:15], s66 offen  lds
    s_waitcnt lgkmcnt(4)
    v_mfma_f32_32x32x16_bf16 v[224:239], v[28:31], a[92:95], v[224:239]
    ds_read_b64_tr_b16 v[24:25], v122 offset:0
    ds_read_b64_tr_b16 v[26:27], v122 offset:512
    s_add_u32 m0, s55, 0
    s_add_u32 s66, s95, 0
    buffer_load_dwordx4 v46, s[12:15], s66 offen  lds
    s_waitcnt lgkmcnt(4)
    v_mfma_f32_32x32x16_bf16 v[224:239], v[32:35], a[96:99], v[224:239]
    ds_read_b64_tr_b16 v[28:29], v123 offset:0
    ds_read_b64_tr_b16 v[30:31], v123 offset:512
    s_add_u32 m0, s55, 1024
    s_add_u32 s66, s95, 8192
    buffer_load_dwordx4 v46, s[12:15], s66 offen  lds
    v_mfma_f32_16x16x32_bf16 v[80:83], v[112:115], v[32:35], v[80:83]
    s_waitcnt lgkmcnt(4)
    v_mfma_f32_32x32x16_bf16 v[224:239], v[36:39], a[100:103], v[224:239]
    ds_read_b64_tr_b16 v[32:33], v120 offset:8192
    ds_read_b64_tr_b16 v[34:35], v120 offset:8704
    v_mfma_f32_16x16x32_bf16 v[80:83], v[112:115], v[36:39], v[80:83]
    s_waitcnt lgkmcnt(4)
    v_mfma_f32_32x32x16_bf16 v[224:239], v[24:27], a[104:107], v[224:239]
    ds_read_b64_tr_b16 v[36:37], v121 offset:8192
    ds_read_b64_tr_b16 v[38:39], v121 offset:8704
    s_waitcnt lgkmcnt(4)
    v_mfma_f32_32x32x16_bf16 v[224:239], v[28:31], a[108:111], v[224:239]
    ds_read_b64_tr_b16 v[24:25], v122 offset:8192
    ds_read_b64_tr_b16 v[26:27], v122 offset:8704
    s_waitcnt lgkmcnt(4)
    v_mfma_f32_32x32x16_bf16 v[224:239], v[32:35], a[112:115], v[224:239]
    ds_read_b64_tr_b16 v[28:29], v123 offset:8192
    ds_read_b64_tr_b16 v[30:31], v123 offset:8704
    v_mfma_f32_16x16x32_bf16 v[80:83], v[112:115], v[32:35], v[80:83]
    s_waitcnt lgkmcnt(4)
    v_mfma_f32_32x32x16_bf16 v[224:239], v[36:39], a[116:119], v[224:239]
    v_mfma_f32_16x16x32_bf16 v[80:83], v[112:115], v[36:39], v[80:83]
    s_waitcnt lgkmcnt(2)
    v_mfma_f32_32x32x16_bf16 v[224:239], v[24:27], a[120:123], v[224:239]
    s_waitcnt lgkmcnt(0)
    v_mfma_f32_32x32x16_bf16 v[224:239], v[28:31], a[124:127], v[224:239]
    s_nop 3
    ds_write_b32 v40, v80
    s_waitcnt lgkmcnt(0)
    s_barrier
    ds_read_b32 v81, v41
    s_add_u32 m0, s96, 32768
    s_add_u32 s66, s92, 262144
    buffer_load_dwordx4 v46, s[12:15], s66 offen  lds
    s_add_u32 m0, s96, 33792
    s_add_u32 s66, s92, 270336
    buffer_load_dwordx4 v46, s[12:15], s66 offen  lds
    s_add_u32 m0, s97, 32768
    s_add_u32 s66, s93, 262144
    buffer_load_dwordx4 v46, s[12:15], s66 offen  lds
    s_add_u32 m0, s97, 33792
    s_add_u32 s66, s93, 270336
    buffer_load_dwordx4 v46, s[12:15], s66 offen  lds
    s_add_u32 m0, s54, 32768
    s_add_u32 s66, s94, 262144
    buffer_load_dwordx4 v46, s[12:15], s66 offen  lds
    s_add_u32 m0, s54, 33792
    s_add_u32 s66, s94, 270336
    buffer_load_dwordx4 v46, s[12:15], s66 offen  lds
    s_add_u32 m0, s55, 32768
    s_add_u32 s66, s95, 262144
    buffer_load_dwordx4 v46, s[12:15], s66 offen  lds
    s_add_u32 m0, s55, 33792
    s_add_u32 s66, s95, 270336
    buffer_load_dwordx4 v46, s[12:15], s66 offen  lds
    s_waitcnt lgkmcnt(0)
    v_add_f32 v80, v80, v81
    v_cvt_pk_bf16_f32 v23, v80, v80
    v_lshlrev_b32 v23, 16, v23
    v_sub_f32 v80, v80, v23
    v_cvt_pk_bf16_f32 v108, v23, v80
    s_nop 1
    v_mfma_f32_32x32x16_bf16 v[224:239], v[108:111], v[96:99], v[224:239]
    buffer_load_dwordx4 v[128:131], v2, s[32:35], s52 offen sc1
    buffer_load_dwordx4 v[132:135], v2, s[32:35], s52 offen offset:1024 sc1
    buffer_load_dwordx4 v[136:139], v2, s[32:35], s52 offen offset:2048 sc1
    buffer_load_dwordx4 v[140:143], v2, s[32:35], s53 offen sc1
    buffer_load_dwordx4 v[144:147], v2, s[32:35], s53 offen offset:1024 sc1
    buffer_load_dwordx4 v[148:151], v2, s[32:35], s53 offen offset:2048 sc1
    s_nop 5
    v_pk_mul_f32 v[224:225], v[224:225], v[44:45] op_sel_hi:[1,0]
    v_pk_mul_f32 v[226:227], v[226:227], v[44:45] op_sel_hi:[1,0]
    v_pk_mul_f32 v[228:229], v[228:229], v[44:45] op_sel_hi:[1,0]
    v_pk_mul_f32 v[230:231], v[230:231], v[44:45] op_sel_hi:[1,0]
    v_pk_mul_f32 v[232:233], v[232:233], v[44:45] op_sel_hi:[1,0]
    v_pk_mul_f32 v[234:235], v[234:235], v[44:45] op_sel_hi:[1,0]
    v_pk_mul_f32 v[236:237], v[236:237], v[44:45] op_sel_hi:[1,0]
    v_pk_mul_f32 v[238:239], v[238:239], v[44:45] op_sel_hi:[1,0]
    v_pk_mul_f32 v[160:161], v[224:225], v[182:183] op_sel_hi:[1,0]
    v_pk_mul_f32 v[162:163], v[226:227], v[182:183] op_sel_hi:[1,0]
    v_pk_mul_f32 v[164:165], v[228:229], v[182:183] op_sel_hi:[1,0]
    v_pk_mul_f32 v[166:167], v[230:231], v[182:183] op_sel_hi:[1,0]
    v_pk_mul_f32 v[168:169], v[232:233], v[182:183] op_sel_hi:[1,0]
    v_pk_mul_f32 v[170:171], v[234:235], v[182:183] op_sel_hi:[1,0]
    v_pk_mul_f32 v[172:173], v[236:237], v[182:183] op_sel_hi:[1,0]
    v_pk_mul_f32 v[174:175], v[238:239], v[182:183] op_sel_hi:[1,0]
    v_exp_f32_e64 v160, v160 clamp
    v_max_f32 v224, 0, v224
    v_exp_f32_e64 v161, v161 clamp
    v_max_f32 v225, 0, v225
    v_exp_f32_e64 v162, v162 clamp
    v_max_f32 v226, 0, v226
    v_exp_f32_e64 v163, v163 clamp
    v_max_f32 v227, 0, v227
    v_exp_f32_e64 v164, v164 clamp
    v_max_f32 v228, 0, v228
    v_exp_f32_e64 v165, v165 clamp
    v_max_f32 v229, 0, v229
    v_exp_f32_e64 v166, v166 clamp
    v_max_f32 v230, 0, v230
    v_exp_f32_e64 v167, v167 clamp
    v_max_f32 v231, 0, v231
    v_exp_f32_e64 v168, v168 clamp
    v_max_f32 v232, 0, v232
    v_exp_f32_e64 v169, v169 clamp
    v_max_f32 v233, 0, v233
    v_exp_f32_e64 v170, v170 clamp
    v_max_f32 v234, 0, v234
    v_exp_f32_e64 v171, v171 clamp
    v_max_f32 v235, 0, v235
    v_exp_f32_e64 v172, v172 clamp
    v_max_f32 v236, 0, v236
    v_exp_f32_e64 v173, v173 clamp
    v_max_f32 v237, 0, v237
    v_exp_f32_e64 v174, v174 clamp
    v_max_f32 v238, 0, v238
    v_exp_f32_e64 v175, v175 clamp
    v_max_f32 v239, 0, v239
    v_pk_add_f32 v[224:225], v[224:225], v[182:183] op_sel:[0,1] op_sel_hi:[1,1]
    v_pk_add_f32 v[226:227], v[226:227], v[182:183] op_sel:[0,1] op_sel_hi:[1,1]
    v_pk_add_f32 v[228:229], v[228:229], v[182:183] op_sel:[0,1] op_sel_hi:[1,1]
    v_pk_add_f32 v[230:231], v[230:231], v[182:183] op_sel:[0,1] op_sel_hi:[1,1]
    v_pk_add_f32 v[232:233], v[232:233], v[182:183] op_sel:[0,1] op_sel_hi:[1,1]
    v_pk_add_f32 v[234:235], v[234:235], v[182:183] op_sel:[0,1] op_sel_hi:[1,1]
    v_pk_add_f32 v[236:237], v[236:237], v[182:183] op_sel:[0,1] op_sel_hi:[1,1]
    v_pk_add_f32 v[238:239], v[238:239], v[182:183] op_sel:[0,1] op_sel_hi:[1,1]
    v_pk_add_f32 v[160:161], v[160:161], v[224:225]
    v_pk_add_f32 v[162:163], v[162:163], v[226:227]
    v_pk_add_f32 v[164:165], v[164:165], v[228:229]
    v_pk_add_f32 v[166:167], v[166:167], v[230:231]
    v_pk_add_f32 v[168:169], v[168:169], v[232:233]
    v_pk_add_f32 v[170:171], v[170:171], v[234:235]
    v_pk_add_f32 v[172:173], v[172:173], v[236:237]
    v_pk_add_f32 v[174:175], v[174:175], v[238:239]
    v_cvt_pk_bf16_f32 v48, v160, v161
    v_cvt_pk_bf16_f32 v49, v162, v163
    v_cvt_pk_bf16_f32 v50, v164, v165
    v_cvt_pk_bf16_f32 v51, v166, v167
    v_cvt_pk_bf16_f32 v52, v168, v169
    v_cvt_pk_bf16_f32 v53, v170, v171
    v_cvt_pk_bf16_f32 v54, v172, v173
    v_cvt_pk_bf16_f32 v55, v174, v175
    v_xor_b32 v24, 32, v20
    v_xor_b32 v25, 64, v20
    v_xor_b32 v26, 64, v21
    s_waitcnt vmcnt(28)
    ds_read_b64_tr_b16 v[64:65], v20 offset:0
    ds_read_b64_tr_b16 v[66:67], v20 offset:1024
    ds_read_b64_tr_b16 v[68:69], v24 offset:0
    ds_read_b64_tr_b16 v[70:71], v24 offset:1024
    ds_read_b64_tr_b16 v[72:73], v25 offset:0
    ds_read_b64_tr_b16 v[74:75], v25 offset:1024
    ds_read_b64_tr_b16 v[76:77], v21 offset:4096
    ds_read_b64_tr_b16 v[78:79], v21 offset:5120
    ds_read_b64_tr_b16 v[80:81], v26 offset:4096
    ds_read_b64_tr_b16 v[82:83], v26 offset:5120
    s_mul_i32 s49, s48, 98304
    s_lshl_b32 s50, s41, 10
    s_add_u32 s49, s49, s50
    s_add_u32 s49, s49, 11534336
    s_cmp_lt_u32 s48, 29
    s_cselect_b32 s49, s49, 0x7f000000
    s_add_u32 s50, s49, 32768
    s_add_u32 s56, s49, 65536
    s_cmp_lt_u32 s48, 28
    s_cselect_b32 s56, s56, 0x7f000000
    s_mul_i32 s57, s39, 172
    s_add_u32 s57, s57, s51
    s_lshl_b32 s57, s57, 10
    s_add_u32 s57, s57, 14680064
    s_cmp_lt_u32 s51, 86
    s_cselect_b32 s57, s57, 0x7f000000
    s_add_u32 s58, s57, 88064
    s_waitcnt lgkmcnt(0)
    buffer_store_dwordx4 v[64:67], v2, s[32:35], s49 offen sc1
    buffer_store_dwordx4 v[68:71], v2, s[32:35], s50 offen sc1
    buffer_store_dwordx4 v[72:75], v2, s[32:35], s56 offen sc1
    buffer_store_dwordx4 v[76:79], v2, s[32:35], s57 offen sc1
    buffer_store_dwordx4 v[80:83], v2, s[32:35], s58 offen sc1
    s_mov_b32 s68, 0
    v_mov_b32 v28, 0x41800000
    s_waitcnt vmcnt(5)
kvp_3:
    v_min_f32 v131, v131, v135
    v_min_f32 v139, v139, v143
    v_min_f32 v147, v147, v151
    v_min3_f32 v131, v131, v139, v147
    v_cmp_neq_f32 vcc, v131, v28
    s_cbranch_vccz kvo_4
    buffer_load_dwordx4 v[128:131], v2, s[32:35], s52 offen sc1
    buffer_load_dwordx4 v[132:135], v2, s[32:35], s52 offen offset:1024 sc1
    buffer_load_dwordx4 v[136:139], v2, s[32:35], s52 offen offset:2048 sc1
    buffer_load_dwordx4 v[140:143], v2, s[32:35], s53 offen sc1
    buffer_load_dwordx4 v[144:147], v2, s[32:35], s53 offen offset:1024 sc1
    buffer_load_dwordx4 v[148:151], v2, s[32:35], s53 offen offset:2048 sc1
    s_add_u32 s68, s68, 1
    s_cmp_gt_u32 s68, 400000
    s_cbranch_scc1 L_end
    s_waitcnt vmcnt(0)
    s_branch kvp_3
kvo_4:
    v_pk_add_f32 v[128:129], v[128:129], v[140:141]
    v_add_f32 v130, v130, v142
    v_pk_add_f32 v[132:133], v[132:133], v[144:145]
    v_add_f32 v134, v134, v146
    v_pk_add_f32 v[136:137], v[136:137], v[148:149]
    v_add_f32 v138, v138, v150
    v_cvt_pk_bf16_f32 v56, v128, v129
    v_cvt_pk_bf16_f32 v57, v130, v132
    v_cvt_pk_bf16_f32 v58, v133, v134
    v_cvt_pk_bf16_f32 v59, v136, v137
    v_mov_b32_dpp v160, v138 row_newbcast:0 row_mask:0xf bank_mask:0xf
    v_mov_b32_dpp v161, v138 row_newbcast:1 row_mask:0xf bank_mask:0xf
    v_mov_b32_dpp v162, v138 row_newbcast:2 row_mask:0xf bank_mask:0xf
    v_mov_b32_dpp v163, v138 row_newbcast:3 row_mask:0xf bank_mask:0xf
    v_mov_b32_dpp v164, v138 row_newbcast:4 row_mask:0xf bank_mask:0xf
    v_mov_b32_dpp v165, v138 row_newbcast:5 row_mask:0xf bank_mask:0xf
    v_mov_b32_dpp v166, v138 row_newbcast:6 row_mask:0xf bank_mask:0xf
    v_mov_b32_dpp v167, v138 row_newbcast:7 row_mask:0xf bank_mask:0xf
    v_cvt_pk_bf16_f32 v60, v160, v161
    v_cvt_pk_bf16_f32 v61, v162, v163
    v_cvt_pk_bf16_f32 v62, v164, v165
    v_cvt_pk_bf16_f32 v63, v166, v167
    v_permlane16_swap_b32 v56, v60
    v_permlane16_swap_b32 v57, v61
    v_permlane16_swap_b32 v58, v62
    v_permlane16_swap_b32 v59, v63
    s_nop 1
    v_mfma_f32_32x32x16_bf16 v[192:207], v[56:59], v[48:51], 0
    v_mfma_f32_32x32x16_bf16 v[208:223], v[60:63], v[52:55], 0
    v_mov_b32_dpp v160, v138 row_newbcast:8 row_mask:0xf bank_mask:0xf
    v_mov_b32_dpp v161, v138 row_newbcast:9 row_mask:0xf bank_mask:0xf
    v_mov_b32_dpp v162, v138 row_newbcast:10 row_mask:0xf bank_mask:0xf
    v_mov_b32_dpp v163, v138 row_newbcast:11 row_mask:0xf bank_mask:0xf
    v_mov_b32_dpp v164, v138 row_newbcast:12 row_mask:0xf bank_mask:0xf
    v_mov_b32_dpp v165, v138 row_newbcast:13 row_mask:0xf bank_mask:0xf
    v_mov_b32_dpp v166, v138 row_newbcast:14 row_mask:0xf bank_mask:0xf
    v_mov_b32_dpp v167, v138 row_newbcast:15 row_mask:0xf bank_mask:0xf
    v_cvt_pk_bf16_f32 v36, v160, v161
    v_cvt_pk_bf16_f32 v37, v162, v163
    v_cvt_pk_bf16_f32 v38, v164, v165
    v_cvt_pk_bf16_f32 v39, v166, v167
    v_add_f32 v28, 0x358637bd, v200
    v_add_f32 v30, 0x358637bd, v216
    v_rcp_f32 v28, v28
    v_rcp_f32 v30, v30
    v_pk_mul_f32 v[192:193], v[192:193], v[28:29] op_sel_hi:[1,0]
    v_pk_mul_f32 v[194:195], v[194:195], v[28:29] op_sel_hi:[1,0]
    v_pk_mul_f32 v[196:197], v[196:197], v[28:29] op_sel_hi:[1,0]
    v_pk_mul_f32 v[198:199], v[198:199], v[28:29] op_sel_hi:[1,0]
    v_cvt_pk_bf16_f32 v48, v192, v193
    v_cvt_pk_bf16_f32 v49, v194, v195
    v_cvt_pk_bf16_f32 v50, v196, v197
    v_cvt_pk_bf16_f32 v51, v198, v199
    buffer_store_dwordx4 v[48:51], v2, s[32:35], s62 offen sc1
    s_nop 0
    v_mfma_f32_32x32x16_bf16 v[160:175], v[36:39], v[48:51], 0
    v_pk_mul_f32 v[208:209], v[208:209], v[30:31] op_sel_hi:[1,0]
    v_pk_mul_f32 v[210:211], v[210:211], v[30:31] op_sel_hi:[1,0]
    v_pk_mul_f32 v[212:213], v[212:213], v[30:31] op_sel_hi:[1,0]
    v_pk_mul_f32 v[214:215], v[214:215], v[30:31] op_sel_hi:[1,0]
    v_cvt_pk_bf16_f32 v52, v208, v209
    v_cvt_pk_bf16_f32 v53, v210, v211
    v_cvt_pk_bf16_f32 v54, v212, v213
    v_cvt_pk_bf16_f32 v55, v214, v215
    buffer_store_dwordx4 v[52:55], v2, s[32:35], s62 offen offset:1024 sc1
    s_nop 0
    v_mfma_f32_32x32x16_bf16 v[64:79], v[36:39], v[52:55], 0
    s_nop 11
    v_add_f32 v28, v160, v72
    v_cvt_pk_bf16_f32 v28, v28, v28
    s_mov_b64 exec, 0xffffffff
    buffer_store_short v28, v47, s[32:35], s63 offen sc1
    s_mov_b64 exec, -1
    s_lshl_b32 s66, s39, 1
    s_and_b32 s67, s40, 1
    s_add_u32 s99, s66, s67
    s_mul_i32 s67, s99, 196608
    s_add_u32 s67, s67, 11534336
    s_lshl_b32 s66, s36, 1
    s_add_u32 s66, s66, s39
    s_and_b32 s84, s66, 7
    s_add_u32 s66, s66, 1
    s_and_b32 s85, s66, 7
    s_lshl_b32 s84, s84, 12
    s_lshl_b32 s85, s85, 12
    s_add_u32 s84, s84, s67
    s_add_u32 s85, s85, s67
    s_lshl_b32 s86, s36, 13
    s_cmp_lt_u32 s99, 14
    s_cselect_b32 s100, s84, 0x7f000000
    s_cselect_b32 s101, s85, 0x7f000000
    s_cmp_lt_u32 s99, 15
    s_cselect_b32 s84, s84, 0x7f000000
    s_cselect_b32 s85, s85, 0x7f000000
    s_lshl_b32 s87, s41, 1
    s_add_u32 s87, s87, s45
    s_mul_i32 s88, s87, 33792
    s_add_u32 s91, s88, 1048576
    s_lshl_b32 s66, s46, 12
    s_add_u32 s88, s91, s66
    s_lshl_b32 s89, s45, 15
    s_add_u32 s90, s89, s66
    s_add_u32 s89, s89, 65536
    v_add_u32 v10, s89, v2
    s_add_u32 s91, s91, 32768
    v_bfe_u32 v14, v1, 2, 2
    v_lshlrev_b32 v14, 6, v14
    v_and_b32 v15, 3, v1
    v_lshl_add_u32 v14, v15, 3, v14
    v_bfe_u32 v15, v1, 4, 1
    v_lshl_add_u32 v14, v15, 5, v14
    v_lshrrev_b32 v15, 5, v1
    v_lshl_add_u32 v14, v15, 9, v14
    v_add_u32 v12, s89, v14
    v_and_b32 v16, 31, v1
    v_lshlrev_b32 v16, 6, v16
    s_lshl_b32 s98, s39, 11
    s_add_u32 s98, s98, 131072
    s_lshl_b32 s60, s87, 5
    s_lshl_b32 s61, s39, 1
    s_add_u32 s61, s61, s46
    s_lshl_b32 s62, s61, 1
    s_add_u32 s60, s60, s62
    s_lshl_b32 s60, s60, 10
    s_add_u32 s60, s60, 3407872
    s_lshl_b32 s62, s87, 4
    s_add_u32 s62, s62, s61
    s_lshl_b32 s63, s62, 7
    s_add_u32 s63, s63, 524288
    s_lshl_b32 s62, s62, 3
    s_add_u32 s62, s62, 12288
    v_lshlrev_b32 v47, 2, v1
    v_lshlrev_b32 v160, 16, v240
    v_and_b32 v161, s69, v240
    v_lshlrev_b32 v162, 16, v241
    v_and_b32 v163, s69, v241
    v_lshlrev_b32 v164, 16, v242
    v_and_b32 v165, s69, v242
    v_lshlrev_b32 v166, 16, v243
    v_and_b32 v167, s69, v243
    v_lshlrev_b32 v168, 16, v244
    v_and_b32 v169, s69, v244
    v_lshlrev_b32 v170, 16, v245
    v_and_b32 v171, s69, v245
    v_lshlrev_b32 v172, 16, v246
    v_and_b32 v173, s69, v246
    v_lshlrev_b32 v174, 16, v247
    v_and_b32 v175, s69, v247
    v_and_b32 v17, 7, v1
    v_lshlrev_b32 v17, 3, v17
    s_lshl_b32 s52, s41, 6
    s_add_u32 s52, s52, 8192
    s_waitcnt vmcnt(0)
    s_barrier
    buffer_store_dwordx2 v[4:5], v249, s[32:35], s64 offen
    buffer_store_dwordx2 v[4:5], v250, s[32:35], s64 offen sc1
    s_mov_b64 exec, 1
    buffer_store_dwordx2 v[4:5], v3, s[32:35], s65 offen sc1
    s_mov_b64 exec, -1
    s_mov_b32 s68, 0
poll_5:
    buffer_load_dwordx2 v[14:15], v17, s[32:35], s52 offen sc1
    s_add_u32 s68, s68, 1
    s_cmp_gt_u32 s68, 400000
    s_cbranch_scc1 L_end
    s_waitcnt vmcnt(0)
    v_cmp_ne_u64 vcc, v[14:15], v[4:5]
    s_cbranch_vccnz poll_5
    s_barrier
    s_add_u32 m0, s90, 65536
    s_add_u32 s52, s88, 0
    buffer_load_dwordx4 v2, s[32:35], s52 offen sc1 lds
    buffer_load_dwordx4 v2, s[32:35], s52 offen offset:1024 sc1 lds
    buffer_load_dwordx4 v2, s[32:35], s52 offen offset:2048 sc1 lds
    ds_read_b64_tr_b16 a[128:129], v13 offset:0
    ds_read_b64_tr_b16 a[130:131], v13 offset:1024
    ds_read_b64_tr_b16 a[132:133], v13 offset:2048
    ds_read_b64_tr_b16 a[134:135], v13 offset:3072
    ds_read_b64_tr_b16 a[136:137], v13 offset:4096
    ds_read_b64_tr_b16 a[138:139], v13 offset:5120
    ds_read_b64_tr_b16 a[140:141], v13 offset:6144
    ds_read_b64_tr_b16 a[142:143], v13 offset:7168
    ds_read_b64_tr_b16 a[144:145], v13 offset:8192
    ds_read_b64_tr_b16 a[146:147], v13 offset:9216
    ds_read_b64_tr_b16 a[148:149], v13 offset:10240
    ds_read_b64_tr_b16 a[150:151], v13 offset:11264
    buffer_load_dwordx4 v2, s[32:35], s52 offen offset:3072 sc1 lds
    ds_read_b64_tr_b16 a[152:153], v13 offset:12288
    ds_read_b64_tr_b16 a[154:155], v13 offset:13312
    ds_read_b64_tr_b16 a[156:157], v13 offset:14336
    ds_read_b64_tr_b16 a[158:159], v13 offset:15360
    ds_read_b64_tr_b16 a[160:161], v13 offset:16384
    ds_read_b64_tr_b16 a[162:163], v13 offset:17408
    ds_read_b64_tr_b16 a[164:165], v13 offset:18432
    ds_read_b64_tr_b16 a[166:167], v13 offset:19456
    ds_read_b64_tr_b16 a[168:169], v13 offset:20480
    ds_read_b64_tr_b16 a[170:171], v13 offset:21504
    ds_read_b64_tr_b16 a[172:173], v13 offset:22528
    ds_read_b64_tr_b16 a[174:175], v13 offset:23552
    s_add_u32 m0, s90, 73728
    s_add_u32 s52, s88, 8192
    buffer_load_dwordx4 v2, s[32:35], s52 offen sc1 lds
    ds_read_b64_tr_b16 a[176:177], v13 offset:24576
    ds_read_b64_tr_b16 a[178:179], v13 offset:25600
    ds_read_b64_tr_b16 a[180:181], v13 offset:26624
    ds_read_b64_tr_b16 a[182:183], v13 offset:27648
    ds_read_b64_tr_b16 a[184:185], v13 offset:28672
    ds_read_b64_tr_b16 a[186:187], v13 offset:29696
    ds_read_b64_tr_b16 a[188:189], v13 offset:30720
    ds_read_b64_tr_b16 a[190:191], v13 offset:31744
    ds_read_b64_tr_b16 a[192:193], v13 offset:32768
    ds_read_b64_tr_b16 a[194:195], v13 offset:33792
    ds_read_b64_tr_b16 a[196:197], v13 offset:34816
    ds_read_b64_tr_b16 a[198:199], v13 offset:35840
    buffer_load_dwordx4 v2, s[32:35], s52 offen offset:1024 sc1 lds
    ds_read_b64_tr_b16 a[200:201], v13 offset:36864
    ds_read_b64_tr_b16 a[202:203], v13 offset:37888
    ds_read_b64_tr_b16 a[204:205], v13 offset:38912
    ds_read_b64_tr_b16 a[206:207], v13 offset:39936
    ds_read_b64_tr_b16 a[208:209], v13 offset:40960
    ds_read_b64_tr_b16 a[210:211], v13 offset:41984
    ds_read_b64_tr_b16 a[212:213], v13 offset:43008
    ds_read_b64_tr_b16 a[214:215], v13 offset:44032
    ds_read_b64_tr_b16 a[216:217], v13 offset:45056
    ds_read_b64_tr_b16 a[218:219], v13 offset:46080
    ds_read_b64_tr_b16 a[220:221], v13 offset:47104
    ds_read_b64_tr_b16 a[222:223], v13 offset:48128
    buffer_load_dwordx4 v2, s[32:35], s52 offen offset:2048 sc1 lds
    ds_read_b64_tr_b16 a[224:225], v13 offset:49152
    ds_read_b64_tr_b16 a[226:227], v13 offset:50176
    ds_read_b64_tr_b16 a[228:229], v13 offset:51200
    ds_read_b64_tr_b16 a[230:231], v13 offset:52224
    ds_read_b64_tr_b16 a[232:233], v13 offset:53248
    ds_read_b64_tr_b16 a[234:235], v13 offset:54272
    ds_read_b64_tr_b16 a[236:237], v13 offset:55296
    ds_read_b64_tr_b16 a[238:239], v13 offset:56320
    ds_read_b64_tr_b16 a[240:241], v13 offset:57344
    ds_read_b64_tr_b16 a[242:243], v13 offset:58368
    ds_read_b64_tr_b16 a[244:245], v13 offset:59392
    ds_read_b64_tr_b16 a[246:247], v13 offset:60416
    buffer_load_dwordx4 v2, s[32:35], s52 offen offset:3072 sc1 lds
    ds_read_b64_tr_b16 a[248:249], v13 offset:61440
    ds_read_b64_tr_b16 a[250:251], v13 offset:62464
    ds_read_b64_tr_b16 a[252:253], v13 offset:63488
    ds_read_b64_tr_b16 a[254:255], v13 offset:64512
    s_waitcnt vmcnt(4) lgkmcnt(0)
    s_barrier
    ds_read_b128 v[24:27], v10 offset:0
    ds_read_b128 v[28:31], v10 offset:1024
    ds_read_b128 v[32:35], v10 offset:2048
    s_waitcnt lgkmcnt(2)
    v_mfma_f32_32x32x16_bf16 v[192:207], a[128:131], v[24:27], 0
    ds_read_b128 v[36:39], v10 offset:3072
    s_add_u32 m0, s90, 81920
    s_add_u32 s52, s88, 16384
    buffer_load_dwordx4 v2, s[32:35], s52 offen sc1 lds
    s_waitcnt lgkmcnt(2)
    v_mfma_f32_32x32x16_bf16 v[192:207], a[132:135], v[28:31], v[192:207]
    ds_read_b128 v[24:27], v10 offset:4096
    buffer_load_dwordx4 v2, s[32:35], s52 offen offset:1024 sc1 lds
    s_waitcnt lgkmcnt(2)
    v_mfma_f32_32x32x16_bf16 v[192:207], a[136:139], v[32:35], v[192:207]
    ds_read_b128 v[28:31], v10 offset:5120
    buffer_load_dwordx4 v2, s[32:35], s52 offen offset:2048 sc1 lds
    s_waitcnt lgkmcnt(2)
    v_mfma_f32_32x32x16_bf16 v[192:207], a[140:143], v[36:39], v[192:207]
    ds_read_b128 v[32:35], v10 offset:6144
    buffer_load_dwordx4 v2, s[32:35], s52 offen offset:3072 sc1 lds
    s_waitcnt lgkmcnt(2)
    v_mfma_f32_32x32x16_bf16 v[192:207], a[144:147], v[24:27], v[192:207]
    ds_read_b128 v[36:39], v10 offset:7168
    s_add_u32 m0, s90, 90112
    s_add_u32 s52, s88, 24576
    buffer_load_dwordx4 v2, s[32:35], s52 offen sc1 lds
    s_waitcnt lgkmcnt(2)
    v_mfma_f32_32x32x16_bf16 v[192:207], a[148:151], v[28:31], v[192:207]
    s_waitcnt vmcnt(5)
    s_barrier
    ds_read_b128 v[24:27], v10 offset:8192
    buffer_load_dwordx4 v2, s[32:35], s52 offen offset:1024 sc1 lds
    s_waitcnt lgkmcnt(2)
    v_mfma_f32_32x32x16_bf16 v[192:207], a[152:155], v[32:35], v[192:207]
    ds_read_b128 v[28:31], v10 offset:9216
    buffer_load_dwordx4 v2, s[32:35], s52 offen offset:2048 sc1 lds
    s_waitcnt lgkmcnt(2)
    v_mfma_f32_32x32x16_bf16 v[192:207], a[156:159], v[36:39], v[192:207]
    ds_read_b128 v[32:35], v10 offset:10240
    buffer_load_dwordx4 v2, s[32:35], s52 offen offset:3072 sc1 lds
    buffer_load_dwordx2 v[14:15], v16, s[32:35], s98 offen sc1
    s_cmp_eq_u32 s2, 0
    s_cselect_b32 s52, 0, 0x7f000000
    s_mov_b64 exec, 1
    buffer_store_dwordx2 v[4:5], v3, s[32:35], s52 offen
    s_mov_b64 exec, -1
    s_waitcnt lgkmcnt(2)
    v_mfma_f32_32x32x16_bf16 v[192:207], a[160:163], v[24:27], v[192:207]
    ds_read_b128 v[36:39], v10 offset:11264
    s_lshr_b32 s67, s40, 1
    s_lshl_b32 s67, s67, 2
    s_waitcnt lgkmcnt(2)
    v_mfma_f32_32x32x16_bf16 v[192:207], a[164:167], v[28:31], v[192:207]
    ds_read_b128 v[24:27], v10 offset:12288
    s_lshl_b32 s59, s37, 3
    s_add_u32 s67, s67, s59
    s_waitcnt lgkmcnt(2)
    v_mfma_f32_32x32x16_bf16 v[192:207], a[168:171], v[32:35], v[192:207]
    ds_read_b128 v[28:31], v10 offset:13312
    s_add_u32 s92, s67, s36
    s_lshl_b32 s93, s92, 15
    s_waitcnt lgkmcnt(2)
    v_mfma_f32_32x32x16_bf16 v[192:207], a[172:175], v[36:39], v[192:207]
    ds_read_b128 v[32:35], v10 offset:14336
    s_add_u32 s93, s93, 3407872
    s_lshl_b32 s94, s92, 11
    s_waitcnt lgkmcnt(2)
    v_mfma_f32_32x32x16_bf16 v[192:207], a[176:179], v[24:27], v[192:207]
    ds_read_b128 v[36:39], v10 offset:15360
    s_add_u32 s94, s94, 524288
    s_lshl_b32 s59, s92, 7
    s_waitcnt lgkmcnt(2)
    v_mfma_f32_32x32x16_bf16 v[192:207], a[180:183], v[28:31], v[192:207]
    s_waitcnt vmcnt(6)
    s_barrier
    ds_read_b128 v[24:27], v10 offset:16384
    s_add_u32 s59, s59, 12288
    v_and_b32 v17, 15, v1
    s_waitcnt lgkmcnt(2)
    v_mfma_f32_32x32x16_bf16 v[192:207], a[184:187], v[32:35], v[192:207]
    ds_read_b128 v[28:31], v10 offset:17408
    v_lshlrev_b32 v17, 3, v17
    v_lshlrev_b32 v8, 2, v1
    s_mov_b32 m0, s89
    s_nop 0
    buffer_load_dwordx4 v2, s[32:35], s91 offen sc1 lds
    s_waitcnt lgkmcnt(2)
    v_mfma_f32_32x32x16_bf16 v[192:207], a[188:191], v[36:39], v[192:207]
    ds_read_b128 v[32:35], v10 offset:18432
    v_add_u32 v9, 65536, v2
    v_add_u32 v11, 131072, v2
    s_waitcnt vmcnt(2)
    v_cmp_ne_u64 vcc, v[14:15], v[4:5]
    s_cbranch_vccnz slow_6
back_7:
    s_waitcnt lgkmcnt(2)
    v_mfma_f32_32x32x16_bf16 v[192:207], a[192:195], v[24:27], v[192:207]
    ds_read_b128 v[36:39], v10 offset:19456
    s_add_u32 s67, s39, 0
    s_and_b32 s67, s67, 7
    s_add_u32 m0, s86, 131072
    s_add_u32 s66, s84, 0
    buffer_load_dwordx4 v2, s[32:35], s66 offen sc1 lds
    s_waitcnt lgkmcnt(2)
    v_mfma_f32_32x32x16_bf16 v[192:207], a[196:199], v[28:31], v[192:207]
    ds_read_b128 v[24:27], v10 offset:20480
    s_lshl_b32 s67, s67, 12
    s_add_u32 s48, s67, s93
    s_waitcnt lgkmcnt(2)
    v_mfma_f32_32x32x16_bf16 v[192:207], a[200:203], v[32:35], v[192:207]
    ds_read_b128 v[28:31], v10 offset:21504
    s_add_u32 s67, s39, 1
    s_and_b32 s67, s67, 7
    buffer_load_dwordx4 v2, s[32:35], s66 offen offset:1024 sc1 lds
    s_waitcnt lgkmcnt(2)
    v_mfma_f32_32x32x16_bf16 v[192:207], a[204:207], v[36:39], v[192:207]
    ds_read_b128 v[32:35], v10 offset:22528
    s_lshl_b32 s67, s67, 12
    s_add_u32 s49, s67, s93
    s_waitcnt lgkmcnt(2)
    v_mfma_f32_32x32x16_bf16 v[192:207], a[208:211], v[24:27], v[192:207]
    ds_read_b128 v[36:39], v10 offset:23552
    s_add_u32 s67, s39, 2
    s_and_b32 s67, s67, 7
    buffer_load_dwordx4 v2, s[32:35], s66 offen offset:2048 sc1 lds
    s_waitcnt lgkmcnt(2)
    v_mfma_f32_32x32x16_bf16 v[192:207], a[212:215], v[28:31], v[192:207]
    s_barrier
    ds_read_b128 v[24:27], v10 offset:24576
    s_lshl_b32 s67, s67, 12
    s_add_u32 s50, s67, s93
    s_waitcnt lgkmcnt(2)
    v_mfma_f32_32x32x16_bf16 v[192:207], a[216:219], v[32:35], v[192:207]
    ds_read_b128 v[28:31], v10 offset:25600
    s_add_u32 s67, s39, 3
    s_and_b32 s67, s67, 7
    buffer_load_dwordx4 v2, s[32:35], s66 offen offset:3072 sc1 lds
    s_waitcnt lgkmcnt(2)
    v_mfma_f32_32x32x16_bf16 v[192:207], a[220:223], v[36:39], v[192:207]
    ds_read_b128 v[32:35], v10 offset:26624
    s_lshl_b32 s67, s67, 12
    s_add_u32 s51, s67, s93
    s_waitcnt lgkmcnt(2)
    v_mfma_f32_32x32x16_bf16 v[192:207], a[224:227], v[24:27], v[192:207]
    ds_read_b128 v[36:39], v10 offset:27648
    s_add_u32 s67, s39, 4
    s_and_b32 s67, s67, 7
    s_add_u32 m0, s86, 135168
    s_add_u32 s66, s85, 0
    buffer_load_dwordx4 v2, s[32:35], s66 offen sc1 lds
    s_waitcnt lgkmcnt(2)
    v_mfma_f32_32x32x16_bf16 v[192:207], a[228:231], v[28:31], v[192:207]
    ds_read_b128 v[24:27], v10 offset:28672
    s_lshl_b32 s67, s67, 12
    s_add_u32 s53, s67, s93
    s_waitcnt lgkmcnt(2)
    v_mfma_f32_32x32x16_bf16 v[192:207], a[232:235], v[32:35], v[192:207]
    ds_read_b128 v[28:31], v10 offset:29696
    s_add_u32 s67, s39, 5
    s_and_b32 s67, s67, 7
    buffer_load_dwordx4 v2, s[32:35], s66 offen offset:1024 sc1 lds
    s_waitcnt lgkmcnt(2)
    v_mfma_f32_32x32x16_bf16 v[192:207], a[236:239], v[36:39], v[192:207]
    ds_read_b128 v[32:35], v10 offset:30720
    s_lshl_b32 s67, s67, 12
    s_add_u32 s54, s67, s93
    s_waitcnt lgkmcnt(2)
    v_mfma_f32_32x32x16_bf16 v[192:207], a[240:243], v[24:27], v[192:207]
    ds_read_b128 v[36:39], v10 offset:31744
    s_add_u32 s67, s39, 6
    s_and_b32 s67, s67, 7
    buffer_load_dwordx4 v2, s[32:35], s66 offen offset:2048 sc1 lds
    s_waitcnt lgkmcnt(2)
    v_mfma_f32_32x32x16_bf16 v[192:207], a[244:247], v[28:31], v[192:207]
    s_lshl_b32 s67, s67, 12
    s_add_u32 s55, s67, s93
    s_waitcnt lgkmcnt(1)
    v_mfma_f32_32x32x16_bf16 v[192:207], a[248:251], v[32:35], v[192:207]
    s_add_u32 s67, s39, 7
    s_and_b32 s67, s67, 7
    buffer_load_dwordx4 v2, s[32:35], s66 offen offset:3072 sc1 lds
    s_waitcnt lgkmcnt(0)
    v_mfma_f32_32x32x16_bf16 v[192:207], a[252:255], v[36:39], v[192:207]
    s_lshl_b32 s67, s67, 12
    s_add_u32 s56, s67, s93
    s_waitcnt vmcnt(8)
    s_barrier
    ds_read_b64_tr_b16 v[24:25], v12
    ds_read_b64_tr_b16 v[26:27], v12 offset:256
    s_add_u32 m0, s86, 0
    s_add_u32 s66, s84, 32768
    buffer_load_dwordx4 v2, s[32:35], s66 offen sc1 lds
    buffer_load_dwordx4 v2, s[32:35], s66 offen offset:1024 sc1 lds
    buffer_load_dwordx4 v2, s[32:35], s66 offen offset:2048 sc1 lds
    buffer_load_dwordx4 v2, s[32:35], s66 offen offset:3072 sc1 lds
    v_pk_add_f32 v[192:193], v[192:193], v[160:161]
    v_pk_add_f32 v[194:195], v[194:195], v[162:163]
    v_pk_add_f32 v[196:197], v[196:197], v[164:165]
    v_pk_add_f32 v[198:199], v[198:199], v[166:167]
    v_pk_add_f32 v[200:201], v[200:201], v[168:169]
    v_pk_add_f32 v[202:203], v[202:203], v[170:171]
    v_pk_add_f32 v[204:205], v[204:205], v[172:173]
    v_pk_add_f32 v[206:207], v[206:207], v[174:175]
    s_waitcnt lgkmcnt(0)
    v_mfma_f32_32x32x16_bf16 v[208:223], v[188:191], v[24:27], 0
    v_cvt_pk_bf16_f32 v240, v192, v193
    v_cvt_pk_bf16_f32 v241, v194, v195
    v_cvt_pk_bf16_f32 v242, v196, v197
    v_cvt_pk_bf16_f32 v243, v198, v199
    v_cvt_pk_bf16_f32 v244, v200, v201
    v_cvt_pk_bf16_f32 v245, v202, v203
    v_cvt_pk_bf16_f32 v246, v204, v205
    v_cvt_pk_bf16_f32 v247, v206, v207
    s_nop 3
    v_add_f32 v28, v248, v208
    v_pk_add_f32 v[192:193], v[192:193], v[28:29] op_sel_hi:[1,0] neg_lo:[0,1] neg_hi:[0,1]
    v_pk_add_f32 v[194:195], v[194:195], v[28:29] op_sel_hi:[1,0] neg_lo:[0,1] neg_hi:[0,1]
    v_pk_add_f32 v[196:197], v[196:197], v[28:29] op_sel_hi:[1,0] neg_lo:[0,1] neg_hi:[0,1]
    v_pk_add_f32 v[198:199], v[198:199], v[28:29] op_sel_hi:[1,0] neg_lo:[0,1] neg_hi:[0,1]
    v_cvt_pk_bf16_f32 v128, v192, v193
    v_cvt_pk_bf16_f32 v129, v194, v195
    v_cvt_pk_bf16_f32 v130, v196, v197
    v_cvt_pk_bf16_f32 v131, v198, v199
    buffer_store_dwordx4 v[128:131], v2, s[32:35], s60 offen sc1
    v_pk_add_f32 v[200:201], v[200:201], v[28:29] op_sel_hi:[1,0] neg_lo:[0,1] neg_hi:[0,1]
    v_pk_add_f32 v[202:203], v[202:203], v[28:29] op_sel_hi:[1,0] neg_lo:[0,1] neg_hi:[0,1]
    v_pk_add_f32 v[204:205], v[204:205], v[28:29] op_sel_hi:[1,0] neg_lo:[0,1] neg_hi:[0,1]
    v_pk_add_f32 v[206:207], v[206:207], v[28:29] op_sel_hi:[1,0] neg_lo:[0,1] neg_hi:[0,1]
    v_cvt_pk_bf16_f32 v132, v200, v201
    v_cvt_pk_bf16_f32 v133, v202, v203
    v_cvt_pk_bf16_f32 v134, v204, v205
    v_cvt_pk_bf16_f32 v135, v206, v207
    buffer_store_dwordx4 v[132:135], v2, s[32:35], s60 offen offset:1024 sc1
    v_dot2_f32_bf16 v24, v128, v128, 0
    v_dot2_f32_bf16 v25, v129, v129, 0
    v_dot2_f32_bf16 v24, v130, v130, v24
    v_dot2_f32_bf16 v25, v131, v131, v25
    v_dot2_f32_bf16 v24, v132, v132, v24
    v_dot2_f32_bf16 v25, v133, v133, v25
    v_dot2_f32_bf16 v24, v134, v134, v24
    v_dot2_f32_bf16 v25, v135, v135, v25
    s_nop 2
    v_add_f32 v24, v24, v25
    v_mov_b32 v25, v24
    s_nop 1
    v_permlane32_swap_b32 v24, v25
    v_add_f32 v24, v24, v25
    s_mov_b64 exec, 0xffffffff
    buffer_store_dword v24, v47, s[32:35], s63 offen sc1
    s_mov_b64 exec, -1
    s_add_u32 m0, s86, 4096
    s_add_u32 s66, s85, 32768
    buffer_load_dwordx4 v2, s[32:35], s66 offen sc1 lds
    buffer_load_dwordx4 v2, s[32:35], s66 offen offset:1024 sc1 lds
    buffer_load_dwordx4 v2, s[32:35], s66 offen offset:2048 sc1 lds
    buffer_load_dwordx4 v2, s[32:35], s66 offen offset:3072 sc1 lds
    s_waitcnt vmcnt(4)
    buffer_store_dwordx2 v[4:5], v249, s[32:35], s62 offen
    buffer_store_dwordx2 v[4:5], v250, s[32:35], s62 offen sc1
    s_cmp_ge_u32 s99, 15
    s_cbranch_scc1 p3skip_8
    s_mov_b32 s68, 0
poll_12:
    buffer_load_dwordx2 v[14:15], v17, s[32:35], s59 offen sc1
    s_add_u32 s68, s68, 1
    s_cmp_gt_u32 s68, 400000
    s_cbranch_scc1 L_end
    s_waitcnt vmcnt(0)
    v_cmp_ne_u64 vcc, v[14:15], v[4:5]
    s_cbranch_vccnz poll_12
    buffer_load_dwordx4 a[0:3], v2, s[32:35], s48 offen sc1
    buffer_load_dwordx4 a[4:7], v2, s[32:35], s48 offen offset:1024 sc1
    buffer_load_dwordx4 a[8:11], v2, s[32:35], s48 offen offset:2048 sc1
    buffer_load_dwordx4 a[12:15], v2, s[32:35], s48 offen offset:3072 sc1
    buffer_load_dwordx4 a[16:19], v2, s[32:35], s49 offen sc1
    buffer_load_dwordx4 a[20:23], v2, s[32:35], s49 offen offset:1024 sc1
    buffer_load_dwordx4 a[24:27], v2, s[32:35], s49 offen offset:2048 sc1
    buffer_load_dwordx4 a[28:31], v2, s[32:35], s49 offen offset:3072 sc1
    s_barrier
    ds_read_b128 v[24:27], v11 offset:0
    ds_read_b128 v[28:31], v2 offset:0
    ds_read_b128 v[48:51], v11 offset:1024
    ds_read_b128 v[52:55], v2 offset:1024
    s_waitcnt lgkmcnt(2)
    s_waitcnt vmcnt(7)
    v_mfma_f32_32x32x16_bf16 v[192:207], v[24:27], a[0:3], 0
    ds_read_b128 v[112:115], v11 offset:2048
    buffer_load_dwordx4 a[32:35], v2, s[32:35], s50 offen sc1
    s_mul_i32 s88, s99, 6
    s_mul_i32 s63, s92, 86
    s_add_u32 s63, s63, s88
    v_mfma_f32_32x32x16_bf16 v[208:223], v[28:31], a[0:3], 0
    ds_read_b128 v[116:119], v2 offset:2048
    buffer_load_dwordx4 a[36:39], v2, s[32:35], s50 offen offset:1024 sc1
    s_lshl_b32 s63, s63, 10
    s_add_u32 s63, s63, 5767168
    s_add_u32 s65, s63, 4096
    s_waitcnt lgkmcnt(2)
    s_waitcnt vmcnt(8)
    v_mfma_f32_32x32x16_bf16 v[192:207], v[48:51], a[4:7], v[192:207]
    ds_read_b128 v[24:27], v11 offset:3072
    buffer_load_dwordx4 a[40:43], v2, s[32:35], s50 offen offset:2048 sc1
    s_mul_i32 s64, s92, 96
    s_add_u32 s64, s64, s88
    s_lshl_b32 s64, s64, 3
    v_mfma_f32_32x32x16_bf16 v[208:223], v[52:55], a[4:7], v[208:223]
    ds_read_b128 v[28:31], v2 offset:3072
    buffer_load_dwordx4 a[44:47], v2, s[32:35], s50 offen offset:3072 sc1
    s_add_u32 s64, s64, 32768
    s_mul_i32 s89, s39, 43
    s_lshr_b32 s89, s89, 7
    s_waitcnt lgkmcnt(2)
    s_waitcnt vmcnt(9)
    v_mfma_f32_32x32x16_bf16 v[192:207], v[112:115], a[8:11], v[192:207]
    ds_read_b128 v[48:51], v11 offset:4096
    buffer_load_dwordx4 a[48:51], v2, s[32:35], s51 offen sc1
    s_mul_i32 s89, s89, 3
    s_sub_u32 s89, s39, s89
    s_mul_i32 s88, s36, 6
    v_mfma_f32_32x32x16_bf16 v[208:223], v[116:119], a[8:11], v[208:223]
    ds_read_b128 v[52:55], v2 offset:4096
    buffer_load_dwordx4 a[52:55], v2, s[32:35], s51 offen offset:1024 sc1
    s_mul_i32 s90, s89, 24
    s_add_u32 s90, s90, s88
    s_add_u32 s89, s89, 1
    s_waitcnt lgkmcnt(2)
    s_waitcnt vmcnt(10)
    v_mfma_f32_32x32x16_bf16 v[192:207], v[24:27], a[12:15], v[192:207]
    ds_read_b128 v[112:115], v11 offset:5120
    buffer_load_dwordx4 a[56:59], v2, s[32:35], s51 offen offset:2048 sc1
    s_cmp_eq_u32 s89, 3
    s_cselect_b32 s89, 0, s89
    s_mul_i32 s91, s89, 24
    v_mfma_f32_32x32x16_bf16 v[208:223], v[28:31], a[12:15], v[208:223]
    ds_read_b128 v[116:119], v2 offset:5120
    buffer_load_dwordx4 a[60:63], v2, s[32:35], s51 offen offset:3072 sc1
    s_add_u32 s91, s91, s88
    s_add_u32 s89, s89, 1
    s_cmp_eq_u32 s89, 3
    s_cselect_b32 s89, 0, s89
    s_waitcnt lgkmcnt(2)
    s_waitcnt vmcnt(11)
    v_mfma_f32_32x32x16_bf16 v[192:207], v[48:51], a[16:19], v[192:207]
    ds_read_b128 v[24:27], v11 offset:6144
    buffer_load_dwordx4 a[64:67], v2, s[32:35], s53 offen sc1
    s_mul_i32 s92, s89, 24
    s_add_u32 s92, s92, s88
    s_add_u32 s89, s89, 1
    v_mfma_f32_32x32x16_bf16 v[208:223], v[52:55], a[16:19], v[208:223]
    ds_read_b128 v[28:31], v2 offset:6144
    buffer_load_dwordx4 a[68:71], v2, s[32:35], s53 offen offset:1024 sc1
    s_cmp_eq_u32 s89, 3
    s_cselect_b32 s89, 0, s89
    s_lshl_b32 s93, s36, 1
    s_waitcnt lgkmcnt(2)
    s_waitcnt vmcnt(12)
    v_mfma_f32_32x32x16_bf16 v[192:207], v[112:115], a[20:23], v[192:207]
    ds_read_b128 v[48:51], v11 offset:7168
    buffer_load_dwordx4 a[72:75], v2, s[32:35], s53 offen offset:2048 sc1
    s_cmp_ge_u32 s36, 2
    s_cselect_b32 s88, 2, 0
    s_cselect_b32 s87, 6, 0
    v_mfma_f32_32x32x16_bf16 v[208:223], v[116:119], a[20:23], v[208:223]
    ds_read_b128 v[52:55], v2 offset:7168
    buffer_load_dwordx4 a[76:79], v2, s[32:35], s53 offen offset:3072 sc1
    s_add_u32 s93, s93, s88
    s_add_u32 s93, s93, 72
    s_add_u32 s87, s87, s36
    s_waitcnt lgkmcnt(2)
    s_waitcnt vmcnt(13)
    v_mfma_f32_32x32x16_bf16 v[192:207], v[24:27], a[24:27], v[192:207]
    ds_read_b128 v[112:115], v11 offset:8192
    buffer_load_dwordx4 a[80:83], v2, s[32:35], s54 offen sc1
    s_add_u32 s87, s87, 76
    s_add_u32 s97, s36, 82
    s_mul_i32 s95, s39, 176128
    v_mfma_f32_32x32x16_bf16 v[208:223], v[28:31], a[24:27], v[208:223]
    ds_read_b128 v[116:119], v2 offset:8192
    buffer_load_dwordx4 a[84:87], v2, s[32:35], s54 offen offset:1024 sc1
    s_add_u32 s95, s95, 14680064
    s_mul_i32 s96, s41, 176128
    s_add_u32 s96, s96, 5767168
    s_waitcnt lgkmcnt(2)
    s_waitcnt vmcnt(14)
    v_mfma_f32_32x32x16_bf16 v[192:207], v[48:51], a[28:31], v[192:207]
    ds_read_b128 v[24:27], v11 offset:9216
    buffer_load_dwordx4 a[88:91], v2, s[32:35], s54 offen offset:2048 sc1
    v_min_u32 v14, 27, v1
    v_cmp_le_u32 vcc, 14, v14
    v_subrev_u32 v15, 14, v14
    v_mfma_f32_32x32x16_bf16 v[208:223], v[52:55], a[28:31], v[208:223]
    ds_read_b128 v[28:31], v2 offset:9216
    buffer_load_dwordx4 a[92:95], v2, s[32:35], s54 offen offset:3072 sc1
    v_mov_b32 v13, 96
    v_cndmask_b32 v14, v14, v15, vcc
    v_cndmask_b32 v12, 0, v13, vcc
    s_waitcnt lgkmcnt(2)
    s_waitcnt vmcnt(15)
    v_mfma_f32_32x32x16_bf16 v[192:207], v[112:115], a[32:35], v[192:207]
    ds_read_b128 v[48:51], v11 offset:10240
    buffer_load_dwordx4 a[96:99], v2, s[32:35], s55 offen sc1
    v_and_b32 v15, 3, v14
    v_cmp_le_u32 vcc, 4, v14
    v_add_u32 v18, s90, v15
    v_mfma_f32_32x32x16_bf16 v[208:223], v[116:119], a[32:35], v[208:223]
    ds_read_b128 v[52:55], v2 offset:10240
    buffer_load_dwordx4 a[100:103], v2, s[32:35], s55 offen offset:1024 sc1
    v_add_u32 v13, s91, v15
    v_cndmask_b32 v18, v18, v13, vcc
    v_cmp_le_u32 vcc, 8, v14
    s_waitcnt lgkmcnt(2)
    s_waitcnt vmcnt(16)
    v_mfma_f32_32x32x16_bf16 v[192:207], v[24:27], a[36:39], v[192:207]
    ds_read_b128 v[112:115], v11 offset:11264
    buffer_load_dwordx4 a[104:107], v2, s[32:35], s55 offen offset:2048 sc1
    v_add_u32 v13, s92, v15
    v_add_u32 v16, s93, v15
    v_cndmask_b32 v18, v18, v13, vcc
    v_mfma_f32_32x32x16_bf16 v[208:223], v[28:31], a[36:39], v[208:223]
    ds_read_b128 v[116:119], v2 offset:11264
    buffer_load_dwordx4 a[108:111], v2, s[32:35], s55 offen offset:3072 sc1
    v_cmp_le_u32 vcc, 12, v14
    v_and_b32 v14, 7, v1
    v_and_b32 v15, 1, v1
    v_cndmask_b32 v18, v18, v16, vcc
    s_waitcnt lgkmcnt(2)
    s_waitcnt vmcnt(17)
    v_mfma_f32_32x32x16_bf16 v[192:207], v[48:51], a[40:43], v[192:207]
    ds_read_b128 v[24:27], v11 offset:12288
    buffer_load_dwordx4 a[112:115], v2, s[32:35], s56 offen sc1
    v_add_u32 v18, v18, v12
    v_lshlrev_b32 v18, 3, v18
    v_cmp_le_u32 vcc, 2, v14
    v_mfma_f32_32x32x16_bf16 v[208:223], v[52:55], a[40:43], v[208:223]
    ds_read_b128 v[28:31], v2 offset:12288
    buffer_load_dwordx4 a[116:119], v2, s[32:35], s56 offen offset:1024 sc1
    v_add_u32 v15, 4, v15
    v_add_u32 v16, s90, v15
    v_add_u32 v13, s91, v15
    v_cndmask_b32 v16, v16, v13, vcc
    s_waitcnt lgkmcnt(2)
    s_waitcnt vmcnt(18)
    v_mfma_f32_32x32x16_bf16 v[192:207], v[112:115], a[44:47], v[192:207]
    ds_read_b128 v[48:51], v11 offset:13312
    buffer_load_dwordx4 a[120:123], v2, s[32:35], s56 offen offset:2048 sc1
    v_cmp_le_u32 vcc, 4, v14
    v_add_u32 v13, s92, v15
    v_bfe_u32 v12, v1, 3, 1
    v_cndmask_b32 v16, v16, v13, vcc
    v_mfma_f32_32x32x16_bf16 v[208:223], v[116:119], a[44:47], v[208:223]
    ds_read_b128 v[52:55], v2 offset:13312
    buffer_load_dwordx4 a[124:127], v2, s[32:35], s56 offen offset:3072 sc1
    v_cmp_eq_u32 vcc, 6, v14
    v_mov_b32 v13, s87
    v_mul_u32_u24 v12, 96, v12
    v_cndmask_b32 v16, v16, v13, vcc
    s_waitcnt lgkmcnt(2)
    s_waitcnt vmcnt(19)
    v_mfma_f32_32x32x16_bf16 v[192:207], v[24:27], a[48:51], v[192:207]
    ds_read_b128 v[112:115], v11 offset:14336
    buffer_load_dword v40, v8, s[32:35], s94 offen sc1
    v_cmp_eq_u32 vcc, 7, v14
    v_mov_b32 v13, s97
    s_mul_i32 s98, s41, 1536
    v_cndmask_b32 v16, v16, v13, vcc
    v_mfma_f32_32x32x16_bf16 v[208:223], v[28:31], a[48:51], v[208:223]
    ds_read_b128 v[116:119], v2 offset:14336
    buffer_load_dword v41, v8, s[32:35], s94 offen offset:256 sc1
    v_add_u32 v16, v16, v12
    v_lshlrev_b32 v16, 3, v16
    s_add_u32 s98, s98, 32768
    s_waitcnt lgkmcnt(2)
    s_waitcnt vmcnt(20)
    v_mfma_f32_32x32x16_bf16 v[192:207], v[48:51], a[52:55], v[192:207]
    ds_read_b128 v[24:27], v11 offset:15360
    buffer_load_dword v42, v8, s[32:35], s94 offen offset:512 sc1
    s_lshl_b32 s90, s90, 10
    s_lshl_b32 s91, s91, 10
    s_lshl_b32 s92, s92, 10
    v_mfma_f32_32x32x16_bf16 v[208:223], v[52:55], a[52:55], v[208:223]
    ds_read_b128 v[28:31], v2 offset:15360
    buffer_load_dword v43, v8, s[32:35], s94 offen offset:768 sc1
    s_lshl_b32 s93, s93, 10
    s_lshl_b32 s87, s87, 10
    s_lshl_b32 s97, s97, 10
    s_waitcnt lgkmcnt(2)
    s_waitcnt vmcnt(21)
    v_mfma_f32_32x32x16_bf16 v[192:207], v[112:115], a[56:59], v[192:207]
    ds_read_b128 v[48:51], v11 offset:16384
    buffer_load_dword v44, v8, s[32:35], s94 offen offset:1024 sc1
    v_and_b32 v14, 31, v1
    v_mul_u32_u24 v14, 272, v14
    v_lshrrev_b32 v15, 5, v1
    v_mfma_f32_32x32x16_bf16 v[208:223], v[116:119], a[56:59], v[208:223]
    ds_read_b128 v[52:55], v2 offset:16384
    buffer_load_dword v45, v8, s[32:35], s94 offen offset:1280 sc1
    v_lshl_add_u32 v14, v15, 4, v14
    s_mul_i32 s88, s36, 8704
    v_add_u32 v12, s88, v14
    s_waitcnt lgkmcnt(2)
    s_waitcnt vmcnt(22)
    v_mfma_f32_32x32x16_bf16 v[192:207], v[24:27], a[60:63], v[192:207]
    ds_read_b128 v[112:115], v11 offset:17408
    buffer_load_dword v46, v8, s[32:35], s94 offen offset:1536 sc1
    s_mul_i32 s88, s45, 43520
    s_lshl_b32 s89, s46, 7
    s_add_u32 s88, s88, s89
    v_mfma_f32_32x32x16_bf16 v[208:223], v[28:31], a[60:63], v[208:223]
    ds_read_b128 v[116:119], v2 offset:17408
    buffer_load_dword v47, v8, s[32:35], s94 offen offset:1792 sc1
    s_add_u32 s88, s88, 34816
    v_add_u32 v121, s88, v14
    v_lshrrev_b32 v14, 3, v1
    s_waitcnt lgkmcnt(2)
    s_waitcnt vmcnt(23)
    v_mfma_f32_32x32x16_bf16 v[192:207], v[48:51], a[64:67], v[192:207]
    ds_read_b128 v[24:27], v11 offset:18432
    buffer_load_dword v252, v251, s[32:35], 0 offen sc1
    v_and_b32 v15, 7, v1
    v_mul_u32_u24 v13, 272, v14
    v_lshl_add_u32 v13, v15, 5, v13
    v_mfma_f32_32x32x16_bf16 v[208:223], v[52:55], a[64:67], v[208:223]
    ds_read_b128 v[28:31], v2 offset:18432
    s_add_u32 m0, s86, 32768
    s_add_u32 s66, s100, 65536
    buffer_load_dwordx4 v2, s[32:35], s66 offen sc1 lds
    s_mul_i32 s88, s36, 2176
    v_add_u32 v13, s88, v13
    v_add_u32 v120, 43520, v13
    s_waitcnt lgkmcnt(2)
    s_waitcnt vmcnt(24)
    v_mfma_f32_32x32x16_bf16 v[192:207], v[112:115], a[68:71], v[192:207]
    ds_read_b128 v[48:51], v11 offset:19456
    v_lshlrev_b32 v10, 10, v14
    v_lshl_add_u32 v10, v15, 4, v10
    s_lshl_b32 s60, s41, 3
    v_mfma_f32_32x32x16_bf16 v[208:223], v[116:119], a[68:71], v[208:223]
    ds_read_b128 v[52:55], v2 offset:19456
    buffer_load_dwordx4 v2, s[32:35], s66 offen offset:1024 sc1 lds
    s_add_u32 s60, s60, s36
    s_lshl_b32 s60, s60, 13
    s_lshl_b32 s88, s39, 7
    s_waitcnt lgkmcnt(2)
    s_waitcnt vmcnt(24)
    v_mfma_f32_32x32x16_bf16 v[192:207], v[24:27], a[72:75], v[192:207]
    ds_read_b128 v[112:115], v11 offset:20480
    s_add_u32 s60, s60, s88
    s_add_u32 s61, s60, 32768
    v_mfma_f32_32x32x16_bf16 v[208:223], v[28:31], a[72:75], v[208:223]
    ds_read_b128 v[116:119], v2 offset:20480
    buffer_load_dwordx4 v2, s[32:35], s66 offen offset:2048 sc1 lds
    s_waitcnt lgkmcnt(2)
    s_waitcnt vmcnt(24)
    v_mfma_f32_32x32x16_bf16 v[192:207], v[48:51], a[76:79], v[192:207]
    ds_read_b128 v[24:27], v11 offset:21504
    s_waitcnt vmcnt(4)
    v_mfma_f32_32x32x16_bf16 v[208:223], v[52:55], a[76:79], v[208:223]
    ds_read_b128 v[28:31], v2 offset:21504
    buffer_load_dwordx4 v2, s[32:35], s66 offen offset:3072 sc1 lds
    v_add_f32 v40, v40, v41
    s_waitcnt lgkmcnt(2)
    v_mfma_f32_32x32x16_bf16 v[192:207], v[112:115], a[80:83], v[192:207]
    ds_read_b128 v[48:51], v11 offset:22528
    v_add_f32 v42, v42, v43
    v_mfma_f32_32x32x16_bf16 v[208:223], v[116:119], a[80:83], v[208:223]
    ds_read_b128 v[52:55], v2 offset:22528
    s_add_u32 m0, s86, 36864
    s_add_u32 s66, s101, 65536
    buffer_load_dwordx4 v2, s[32:35], s66 offen sc1 lds
    v_add_f32 v44, v44, v45
    s_waitcnt lgkmcnt(2)
    v_mfma_f32_32x32x16_bf16 v[192:207], v[24:27], a[84:87], v[192:207]
    ds_read_b128 v[112:115], v11 offset:23552
    v_add_f32 v46, v46, v47
    v_mfma_f32_32x32x16_bf16 v[208:223], v[28:31], a[84:87], v[208:223]
    ds_read_b128 v[116:119], v2 offset:23552
    buffer_load_dwordx4 v2, s[32:35], s66 offen offset:1024 sc1 lds
    v_add_f32 v40, v40, v42
    s_waitcnt lgkmcnt(2)
    v_mfma_f32_32x32x16_bf16 v[192:207], v[48:51], a[88:91], v[192:207]
    ds_read_b128 v[24:27], v11 offset:24576
    v_add_f32 v44, v44, v46
    v_mfma_f32_32x32x16_bf16 v[208:223], v[52:55], a[88:91], v[208:223]
    ds_read_b128 v[28:31], v2 offset:24576
    buffer_load_dwordx4 v2, s[32:35], s66 offen offset:2048 sc1 lds
    v_add_f32 v40, v40, v44
    s_waitcnt lgkmcnt(2)
    v_mfma_f32_32x32x16_bf16 v[192:207], v[112:115], a[92:95], v[192:207]
    ds_read_b128 v[48:51], v11 offset:25600
    v_mov_b32 v41, v40
    v_mfma_f32_32x32x16_bf16 v[208:223], v[116:119], a[92:95], v[208:223]
    ds_read_b128 v[52:55], v2 offset:25600
    buffer_load_dwordx4 v2, s[32:35], s66 offen offset:3072 sc1 lds
    v_permlane32_swap_b32 v40, v41
    s_waitcnt lgkmcnt(2)
    v_mfma_f32_32x32x16_bf16 v[192:207], v[24:27], a[96:99], v[192:207]
    ds_read_b128 v[112:115], v11 offset:26624
    v_add_f32 v40, v40, v41
    v_mfma_f32_32x32x16_bf16 v[208:223], v[28:31], a[96:99], v[208:223]
    ds_read_b128 v[116:119], v2 offset:26624
    s_add_u32 m0, s86, 65536
    s_add_u32 s66, s100, 98304
    buffer_load_dwordx4 v2, s[32:35], s66 offen sc1 lds
    v_mul_f32 v40, 0x3b000000, v40
    s_waitcnt lgkmcnt(2)
    v_mfma_f32_32x32x16_bf16 v[192:207], v[48:51], a[100:103], v[192:207]
    ds_read_b128 v[24:27], v11 offset:27648
    v_cvt_pk_bf16_f32 v41, v40, v40
    v_mfma_f32_32x32x16_bf16 v[208:223], v[52:55], a[100:103], v[208:223]
    ds_read_b128 v[28:31], v2 offset:27648
    buffer_load_dwordx4 v2, s[32:35], s66 offen offset:1024 sc1 lds
    v_lshlrev_b32 v40, 16, v41
    s_waitcnt lgkmcnt(2)
    v_mfma_f32_32x32x16_bf16 v[192:207], v[112:115], a[104:107], v[192:207]
    ds_read_b128 v[48:51], v11 offset:28672
    v_add_f32 v40, 0x3727c5ac, v40
    v_mfma_f32_32x32x16_bf16 v[208:223], v[116:119], a[104:107], v[208:223]
    ds_read_b128 v[52:55], v2 offset:28672
    buffer_load_dwordx4 v2, s[32:35], s66 offen offset:2048 sc1 lds
    v_cvt_pk_bf16_f32 v41, v40, v40
    s_waitcnt lgkmcnt(2)
    v_mfma_f32_32x32x16_bf16 v[192:207], v[24:27], a[108:111], v[192:207]
    ds_read_b128 v[112:115], v11 offset:29696
    v_lshlrev_b32 v40, 16, v41
    v_mfma_f32_32x32x16_bf16 v[208:223], v[28:31], a[108:111], v[208:223]
    ds_read_b128 v[116:119], v2 offset:29696
    buffer_load_dwordx4 v2, s[32:35], s66 offen offset:3072 sc1 lds
    v_sqrt_f32 v40, v40
    s_waitcnt lgkmcnt(2)
    v_mfma_f32_32x32x16_bf16 v[192:207], v[48:51], a[112:115], v[192:207]
    ds_read_b128 v[24:27], v11 offset:30720
    v_cvt_pk_bf16_f32 v41, v40, v40
    v_mfma_f32_32x32x16_bf16 v[208:223], v[52:55], a[112:115], v[208:223]
    ds_read_b128 v[28:31], v2 offset:30720
    s_add_u32 m0, s86, 69632
    s_add_u32 s66, s101, 98304
    buffer_load_dwordx4 v2, s[32:35], s66 offen sc1 lds
    v_lshlrev_b32 v40, 16, v41
    s_waitcnt lgkmcnt(2)
    v_mfma_f32_32x32x16_bf16 v[192:207], v[112:115], a[116:119], v[192:207]
    ds_read_b128 v[48:51], v11 offset:31744
    v_rcp_f32 v41, v40
    v_mfma_f32_32x32x16_bf16 v[208:223], v[116:119], a[116:119], v[208:223]
    ds_read_b128 v[52:55], v2 offset:31744
    buffer_load_dwordx4 v2, s[32:35], s66 offen offset:1024 sc1 lds
    v_mul_f32 v19, v40, v40
    s_waitcnt lgkmcnt(2)
    v_mfma_f32_32x32x16_bf16 v[192:207], v[24:27], a[120:123], v[192:207]
    s_cmp_eq_u32 s99, 14
    s_cbranch_scc1 p3short_9
    s_waitcnt vmcnt(6)
    s_barrier
    ds_read_b128 v[112:115], v2 offset:32768
    v_mul_f32 v20, 0xc0135761, v41
    v_mfma_f32_32x32x16_bf16 v[208:223], v[28:31], a[120:123], v[208:223]
    ds_read_b128 v[116:119], v2 offset:33792
    buffer_load_dwordx4 v2, s[32:35], s66 offen offset:2048 sc1 lds
    v_mul_f32 v41, v41, v41
    s_waitcnt lgkmcnt(2)
    v_mfma_f32_32x32x16_bf16 v[192:207], v[48:51], a[124:127], v[192:207]
    ds_read_b128 v[24:27], v2 offset:34816
    v_mul_f32 v41, 0x3d372713, v41
    v_mfma_f32_32x32x16_bf16 v[208:223], v[52:55], a[124:127], v[208:223]
    ds_read_b128 v[28:31], v2 offset:35840
    buffer_load_dwordx4 v2, s[32:35], s66 offen offset:3072 sc1 lds
    v_mul_f32 v21, v20, v41
    s_waitcnt lgkmcnt(2)
    v_mfma_f32_32x32x16_bf16 v[224:239], v[112:115], a[0:3], 0
    ds_read_b128 v[48:51], v2 offset:36864
    v_mfma_f32_32x32x16_bf16 v[224:239], v[116:119], a[4:7], v[224:239]
    ds_read_b128 v[52:55], v2 offset:37888
    s_add_u32 m0, s86, 98304
    s_add_u32 s66, s100, 131072
    buffer_load_dwordx4 v2, s[32:35], s66 offen sc1 lds
    v_mul_f32 v32, v192, v192
    v_mul_f32 v33, v193, v193
    v_mul_f32 v34, v194, v194
    s_waitcnt lgkmcnt(2)
    v_mfma_f32_32x32x16_bf16 v[224:239], v[24:27], a[8:11], v[224:239]
    ds_read_b128 v[112:115], v2 offset:38912
    v_mul_f32 v35, v195, v195
    v_fma_f32 v32, v32, v21, v20
    v_fma_f32 v33, v33, v21, v20
    v_mfma_f32_32x32x16_bf16 v[224:239], v[28:31], a[12:15], v[224:239]
    ds_read_b128 v[116:119], v2 offset:39936
    buffer_load_dwordx4 v2, s[32:35], s66 offen offset:1024 sc1 lds
    v_fma_f32 v34, v34, v21, v20
    v_fma_f32 v35, v35, v21, v20
    v_mul_f32 v32, v32, v192
    s_waitcnt lgkmcnt(2)
    v_mfma_f32_32x32x16_bf16 v[224:239], v[48:51], a[16:19], v[224:239]
    ds_read_b128 v[24:27], v2 offset:40960
    v_mul_f32 v33, v33, v193
    v_mul_f32 v34, v34, v194
    v_mul_f32 v35, v35, v195
    v_mfma_f32_32x32x16_bf16 v[224:239], v[52:55], a[20:23], v[224:239]
    ds_read_b128 v[28:31], v2 offset:41984
    buffer_load_dwordx4 v2, s[32:35], s66 offen offset:2048 sc1 lds
    v_exp_f32 v32, v32
    v_mul_f32 v192, v192, v200
    v_exp_f32 v33, v33
    s_waitcnt lgkmcnt(2)
    v_mfma_f32_32x32x16_bf16 v[224:239], v[112:115], a[24:27], v[224:239]
    ds_read_b128 v[48:51], v2 offset:43008
    v_mul_f32 v193, v193, v201
    v_exp_f32 v34, v34
    v_mul_f32 v194, v194, v202
    v_mfma_f32_32x32x16_bf16 v[224:239], v[116:119], a[28:31], v[224:239]
    ds_read_b128 v[52:55], v2 offset:44032
    buffer_load_dwordx4 v2, s[32:35], s66 offen offset:3072 sc1 lds
    v_exp_f32 v35, v35
    v_mul_f32 v195, v195, v203
    v_fma_f32 v32, v32, v19, v19
    s_waitcnt lgkmcnt(2)
    v_mfma_f32_32x32x16_bf16 v[224:239], v[24:27], a[32:35], v[224:239]
    ds_read_b128 v[112:115], v2 offset:45056
    v_fma_f32 v33, v33, v19, v19
    v_fma_f32 v34, v34, v19, v19
    v_fma_f32 v35, v35, v19, v19
    v_mfma_f32_32x32x16_bf16 v[224:239], v[28:31], a[36:39], v[224:239]
    ds_read_b128 v[116:119], v2 offset:46080
    s_add_u32 m0, s86, 102400
    s_add_u32 s66, s101, 131072
    buffer_load_dwordx4 v2, s[32:35], s66 offen sc1 lds
    v_rcp_f32 v32, v32
    v_rcp_f32 v33, v33
    v_rcp_f32 v34, v34
    s_waitcnt lgkmcnt(2)
    v_mfma_f32_32x32x16_bf16 v[224:239], v[48:51], a[40:43], v[224:239]
    ds_read_b128 v[24:27], v2 offset:47104
    v_rcp_f32 v35, v35
    v_mul_f32 v192, v192, v32
    v_mul_f32 v193, v193, v33
    v_mfma_f32_32x32x16_bf16 v[224:239], v[52:55], a[44:47], v[224:239]
    ds_read_b128 v[28:31], v2 offset:48128
    buffer_load_dwordx4 v2, s[32:35], s66 offen offset:1024 sc1 lds
    v_mul_f32 v194, v194, v34
    v_mul_f32 v195, v195, v35
    v_cvt_pk_bf16_f32 v56, v192, v193
    s_waitcnt lgkmcnt(2)
    v_mfma_f32_32x32x16_bf16 v[224:239], v[112:115], a[48:51], v[224:239]
    ds_read_b128 v[48:51], v2 offset:49152
    v_cvt_pk_bf16_f32 v57, v194, v195
    v_mul_f32 v36, v196, v196
    v_mul_f32 v37, v197, v197
    v_mfma_f32_32x32x16_bf16 v[224:239], v[116:119], a[52:55], v[224:239]
    ds_read_b128 v[52:55], v2 offset:50176
    buffer_load_dwordx4 v2, s[32:35], s66 offen offset:2048 sc1 lds
    v_mul_f32 v38, v198, v198
    v_mul_f32 v39, v199, v199
    v_fma_f32 v36, v36, v21, v20
    s_waitcnt lgkmcnt(2)
    v_mfma_f32_32x32x16_bf16 v[224:239], v[24:27], a[56:59], v[224:239]
    ds_read_b128 v[112:115], v2 offset:51200
    v_fma_f32 v37, v37, v21, v20
    v_fma_f32 v38, v38, v21, v20
    v_fma_f32 v39, v39, v21, v20
    v_mfma_f32_32x32x16_bf16 v[224:239], v[28:31], a[60:63], v[224:239]
    ds_read_b128 v[116:119], v2 offset:52224
    buffer_load_dwordx4 v2, s[32:35], s66 offen offset:3072 sc1 lds
    v_mul_f32 v36, v36, v196
    v_mul_f32 v37, v37, v197
    v_mul_f32 v38, v38, v198
    s_waitcnt lgkmcnt(2)
    v_mfma_f32_32x32x16_bf16 v[224:239], v[48:51], a[64:67], v[224:239]
    ds_read_b128 v[24:27], v2 offset:53248
    v_mul_f32 v39, v39, v199
    v_exp_f32 v36, v36
    v_mul_f32 v196, v196, v204
    v_mfma_f32_32x32x16_bf16 v[224:239], v[52:55], a[68:71], v[224:239]
    ds_read_b128 v[28:31], v2 offset:54272
    s_add_u32 s67, s95, s90
    buffer_load_dwordx4 a[128:131], v2, s[32:35], s67 offen sc1
    v_exp_f32 v37, v37
    v_mul_f32 v197, v197, v205
    v_exp_f32 v38, v38
    s_waitcnt lgkmcnt(2)
    v_mfma_f32_32x32x16_bf16 v[224:239], v[112:115], a[72:75], v[224:239]
    ds_read_b128 v[48:51], v2 offset:55296
    v_mul_f32 v198, v198, v206
    v_exp_f32 v39, v39
    v_mul_f32 v199, v199, v207
    v_mfma_f32_32x32x16_bf16 v[224:239], v[116:119], a[76:79], v[224:239]
    ds_read_b128 v[52:55], v2 offset:56320
    buffer_load_dwordx4 a[136:139], v2, s[32:35], s67 offen offset:1024 sc1
    v_fma_f32 v36, v36, v19, v19
    v_fma_f32 v37, v37, v19, v19
    v_fma_f32 v38, v38, v19, v19
    s_waitcnt lgkmcnt(2)
    v_mfma_f32_32x32x16_bf16 v[224:239], v[24:27], a[80:83], v[224:239]
    ds_read_b128 v[112:115], v2 offset:57344
    v_fma_f32 v39, v39, v19, v19
    v_rcp_f32 v36, v36
    v_rcp_f32 v37, v37
    v_mfma_f32_32x32x16_bf16 v[224:239], v[28:31], a[84:87], v[224:239]
    ds_read_b128 v[116:119], v2 offset:58368
    buffer_load_dwordx4 a[144:147], v2, s[32:35], s67 offen offset:2048 sc1
    v_rcp_f32 v38, v38
    v_rcp_f32 v39, v39
    v_mul_f32 v196, v196, v36
    s_waitcnt lgkmcnt(2)
    v_mfma_f32_32x32x16_bf16 v[224:239], v[48:51], a[88:91], v[224:239]
    ds_read_b128 v[24:27], v2 offset:59392
    v_mul_f32 v197, v197, v37
    v_mul_f32 v198, v198, v38
    v_mul_f32 v199, v199, v39
    v_mfma_f32_32x32x16_bf16 v[224:239], v[52:55], a[92:95], v[224:239]
    ds_read_b128 v[28:31], v2 offset:60416
    buffer_load_dwordx4 a[152:155], v2, s[32:35], s67 offen offset:3072 sc1
    v_cvt_pk_bf16_f32 v58, v196, v197
    v_cvt_pk_bf16_f32 v59, v198, v199
    buffer_store_dwordx4 v[56:59], v2, s[32:35], s63 offen sc1
    s_waitcnt lgkmcnt(2)
    v_mfma_f32_32x32x16_bf16 v[224:239], v[112:115], a[96:99], v[224:239]
    ds_read_b128 v[48:51], v2 offset:61440
    v_mul_f32 v32, v208, v208
    v_mul_f32 v33, v209, v209
    v_mul_f32 v34, v210, v210
    v_mfma_f32_32x32x16_bf16 v[224:239], v[116:119], a[100:103], v[224:239]
    ds_read_b128 v[52:55], v2 offset:62464
    s_add_u32 s67, s95, s90
    s_add_u32 s67, s67, 88064
    buffer_load_dwordx4 a[132:135], v2, s[32:35], s67 offen sc1
    v_mul_f32 v35, v211, v211
    v_fma_f32 v32, v32, v21, v20
    v_fma_f32 v33, v33, v21, v20
    s_waitcnt lgkmcnt(2)
    v_mfma_f32_32x32x16_bf16 v[224:239], v[24:27], a[104:107], v[224:239]
    ds_read_b128 v[112:115], v2 offset:63488
    v_fma_f32 v34, v34, v21, v20
    v_fma_f32 v35, v35, v21, v20
    v_mul_f32 v32, v32, v208
    v_mfma_f32_32x32x16_bf16 v[224:239], v[28:31], a[108:111], v[224:239]
    ds_read_b128 v[116:119], v2 offset:64512
    buffer_load_dwordx4 a[140:143], v2, s[32:35], s67 offen offset:1024 sc1
    v_mul_f32 v33, v33, v209
    v_mul_f32 v34, v34, v210
    v_mul_f32 v35, v35, v211
    s_waitcnt lgkmcnt(2)
    v_mfma_f32_32x32x16_bf16 v[224:239], v[48:51], a[112:115], v[224:239]
    s_waitcnt vmcnt(15)
    s_barrier
    ds_read_b128 v[24:27], v9 offset:0
    v_exp_f32 v32, v32
    v_mul_f32 v208, v208, v216
    v_exp_f32 v33, v33
    v_mfma_f32_32x32x16_bf16 v[224:239], v[52:55], a[116:119], v[224:239]
    ds_read_b128 v[28:31], v9 offset:1024
    s_add_u32 m0, s86, 131072
    s_add_u32 s66, s100, 163840
    buffer_load_dwordx4 v2, s[32:35], s66 offen sc1 lds
    v_mul_f32 v209, v209, v217
    v_exp_f32 v34, v34
    v_mul_f32 v210, v210, v218
    s_waitcnt lgkmcnt(2)
    v_mfma_f32_32x32x16_bf16 v[224:239], v[112:115], a[120:123], v[224:239]
    ds_read_b128 v[48:51], v9 offset:2048
    v_exp_f32 v35, v35
    v_mul_f32 v211, v211, v219
    v_fma_f32 v32, v32, v19, v19
    v_mfma_f32_32x32x16_bf16 v[224:239], v[116:119], a[124:127], v[224:239]
    ds_read_b128 v[52:55], v9 offset:3072
    buffer_load_dwordx4 v2, s[32:35], s66 offen offset:1024 sc1 lds
    v_fma_f32 v33, v33, v19, v19
    v_fma_f32 v34, v34, v19, v19
    v_fma_f32 v35, v35, v19, v19
    s_waitcnt lgkmcnt(2)
    v_mfma_f32_32x32x16_bf16 v[192:207], v[24:27], a[0:3], 0
    ds_read_b128 v[112:115], v9 offset:4096
    v_rcp_f32 v32, v32
    v_rcp_f32 v33, v33
    v_rcp_f32 v34, v34
    v_mfma_f32_32x32x16_bf16 v[192:207], v[28:31], a[4:7], v[192:207]
    ds_read_b128 v[116:119], v9 offset:5120
    buffer_load_dwordx4 v2, s[32:35], s66 offen offset:2048 sc1 lds
    v_rcp_f32 v35, v35
    v_mul_f32 v208, v208, v32
    v_mul_f32 v209, v209, v33
    s_waitcnt lgkmcnt(2)
    v_mfma_f32_32x32x16_bf16 v[192:207], v[48:51], a[8:11], v[192:207]
    ds_read_b128 v[24:27], v9 offset:6144
    v_mul_f32 v210, v210, v34
    v_mul_f32 v211, v211, v35
    v_cvt_pk_bf16_f32 v60, v208, v209
    v_mfma_f32_32x32x16_bf16 v[192:207], v[52:55], a[12:15], v[192:207]
    ds_read_b128 v[28:31], v9 offset:7168
    buffer_load_dwordx4 v2, s[32:35], s66 offen offset:3072 sc1 lds
    v_cvt_pk_bf16_f32 v61, v210, v211
    v_mul_f32 v36, v212, v212
    v_mul_f32 v37, v213, v213
    s_waitcnt lgkmcnt(2)
    v_mfma_f32_32x32x16_bf16 v[192:207], v[112:115], a[16:19], v[192:207]
    ds_read_b128 v[48:51], v9 offset:8192
    v_mul_f32 v38, v214, v214
    v_mul_f32 v39, v215, v215
    v_fma_f32 v36, v36, v21, v20
    v_mfma_f32_32x32x16_bf16 v[192:207], v[116:119], a[20:23], v[192:207]
    ds_read_b128 v[52:55], v9 offset:9216
    s_add_u32 m0, s86, 135168
    s_add_u32 s66, s101, 163840
    buffer_load_dwordx4 v2, s[32:35], s66 offen sc1 lds
    v_fma_f32 v37, v37, v21, v20
    v_fma_f32 v38, v38, v21, v20
    v_fma_f32 v39, v39, v21, v20
    s_waitcnt lgkmcnt(2)
    v_mfma_f32_32x32x16_bf16 v[192:207], v[24:27], a[24:27], v[192:207]
    ds_read_b128 v[112:115], v9 offset:10240
    v_mul_f32 v36, v36, v212
    v_mul_f32 v37, v37, v213
    v_mul_f32 v38, v38, v214
    v_mfma_f32_32x32x16_bf16 v[192:207], v[28:31], a[28:31], v[192:207]
    ds_read_b128 v[116:119], v9 offset:11264
    buffer_load_dwordx4 v2, s[32:35], s66 offen offset:1024 sc1 lds
    v_mul_f32 v39, v39, v215
    v_exp_f32 v36, v36
    v_mul_f32 v212, v212, v220
    s_waitcnt lgkmcnt(2)
    v_mfma_f32_32x32x16_bf16 v[192:207], v[48:51], a[32:35], v[192:207]
    ds_read_b128 v[24:27], v9 offset:12288
    v_exp_f32 v37, v37
    v_mul_f32 v213, v213, v221
    v_exp_f32 v38, v38
    v_mfma_f32_32x32x16_bf16 v[192:207], v[52:55], a[36:39], v[192:207]
    ds_read_b128 v[28:31], v9 offset:13312
    buffer_load_dwordx4 v2, s[32:35], s66 offen offset:2048 sc1 lds
    v_mul_f32 v214, v214, v222
    v_exp_f32 v39, v39
    v_mul_f32 v215, v215, v223
    s_waitcnt lgkmcnt(2)
    v_mfma_f32_32x32x16_bf16 v[192:207], v[112:115], a[40:43], v[192:207]
    ds_read_b128 v[48:51], v9 offset:14336
    v_fma_f32 v36, v36, v19, v19
    v_fma_f32 v37, v37, v19, v19
    v_fma_f32 v38, v38, v19, v19
    v_mfma_f32_32x32x16_bf16 v[192:207], v[116:119], a[44:47], v[192:207]
    ds_read_b128 v[52:55], v9 offset:15360
    buffer_load_dwordx4 v2, s[32:35], s66 offen offset:3072 sc1 lds
    v_fma_f32 v39, v39, v19, v19
    v_rcp_f32 v36, v36
    v_rcp_f32 v37, v37
    s_waitcnt lgkmcnt(2)
    v_mfma_f32_32x32x16_bf16 v[192:207], v[24:27], a[48:51], v[192:207]
    ds_read_b128 v[112:115], v9 offset:16384
    v_rcp_f32 v38, v38
    v_rcp_f32 v39, v39
    v_mul_f32 v212, v212, v36
    v_mfma_f32_32x32x16_bf16 v[192:207], v[28:31], a[52:55], v[192:207]
    ds_read_b128 v[116:119], v9 offset:17408
    buffer_load_dwordx4 a[148:151], v2, s[32:35], s67 offen offset:2048 sc1
    v_mul_f32 v213, v213, v37
    v_mul_f32 v214, v214, v38
    v_mul_f32 v215, v215, v39
    s_waitcnt lgkmcnt(2)
    v_mfma_f32_32x32x16_bf16 v[192:207], v[48:51], a[56:59], v[192:207]
    ds_read_b128 v[24:27], v9 offset:18432
    v_cvt_pk_bf16_f32 v62, v212, v213
    v_cvt_pk_bf16_f32 v63, v214, v215
    buffer_store_dwordx4 v[60:63], v2, s[32:35], s63 offen offset:1024 sc1
    v_mfma_f32_32x32x16_bf16 v[192:207], v[52:55], a[60:63], v[192:207]
    ds_read_b128 v[28:31], v9 offset:19456
    buffer_load_dwordx4 a[156:159], v2, s[32:35], s67 offen offset:3072 sc1
    s_waitcnt vmcnt(13)
    buffer_store_dwordx2 v[4:5], v249, s[32:35], s64 offen
    buffer_store_dwordx2 v[4:5], v250, s[32:35], s64 offen sc1
    v_mul_f32 v32, v224, v224
    v_mul_f32 v33, v225, v225
    s_waitcnt lgkmcnt(2)
    v_mfma_f32_32x32x16_bf16 v[192:207], v[112:115], a[64:67], v[192:207]
    ds_read_b128 v[48:51], v9 offset:20480
    v_mul_f32 v34, v226, v226
    v_mul_f32 v35, v227, v227
    v_fma_f32 v32, v32, v21, v20
    v_mfma_f32_32x32x16_bf16 v[192:207], v[116:119], a[68:71], v[192:207]
    ds_read_b128 v[52:55], v9 offset:21504
    s_add_u32 s67, s95, s91
    buffer_load_dwordx4 a[176:179], v2, s[32:35], s67 offen sc1
    v_fma_f32 v33, v33, v21, v20
    v_fma_f32 v34, v34, v21, v20
    v_fma_f32 v35, v35, v21, v20
    s_waitcnt lgkmcnt(2)
    v_mfma_f32_32x32x16_bf16 v[192:207], v[24:27], a[72:75], v[192:207]
    ds_read_b128 v[112:115], v9 offset:22528
    v_mul_f32 v32, v32, v224
    v_mul_f32 v33, v33, v225
    v_mul_f32 v34, v34, v226
    v_mfma_f32_32x32x16_bf16 v[192:207], v[28:31], a[76:79], v[192:207]
    ds_read_b128 v[116:119], v9 offset:23552
    buffer_load_dwordx4 a[184:187], v2, s[32:35], s67 offen offset:1024 sc1
    v_mul_f32 v35, v35, v227
    v_exp_f32 v32, v32
    v_mul_f32 v224, v224, v232
    s_waitcnt lgkmcnt(2)
    v_mfma_f32_32x32x16_bf16 v[192:207], v[48:51], a[80:83], v[192:207]
    ds_read_b128 v[24:27], v9 offset:24576
    v_exp_f32 v33, v33
    v_mul_f32 v225, v225, v233
    v_exp_f32 v34, v34
    v_mfma_f32_32x32x16_bf16 v[192:207], v[52:55], a[84:87], v[192:207]
    ds_read_b128 v[28:31], v9 offset:25600
    buffer_load_dwordx4 a[192:195], v2, s[32:35], s67 offen offset:2048 sc1
    v_mul_f32 v226, v226, v234
    v_exp_f32 v35, v35
    v_mul_f32 v227, v227, v235
    s_waitcnt lgkmcnt(2)
    v_mfma_f32_32x32x16_bf16 v[192:207], v[112:115], a[88:91], v[192:207]
    ds_read_b128 v[48:51], v9 offset:26624
    v_fma_f32 v32, v32, v19, v19
    v_fma_f32 v33, v33, v19, v19
    v_fma_f32 v34, v34, v19, v19
    v_mfma_f32_32x32x16_bf16 v[192:207], v[116:119], a[92:95], v[192:207]
    ds_read_b128 v[52:55], v9 offset:27648
    buffer_load_dwordx4 a[200:203], v2, s[32:35], s67 offen offset:3072 sc1
    v_fma_f32 v35, v35, v19, v19
    v_rcp_f32 v32, v32
    v_rcp_f32 v33, v33
    s_waitcnt lgkmcnt(2)
    v_mfma_f32_32x32x16_bf16 v[192:207], v[24:27], a[96:99], v[192:207]
    ds_read_b128 v[112:115], v9 offset:28672
    v_rcp_f32 v34, v34
    v_rcp_f32 v35, v35
    v_mul_f32 v224, v224, v32
    v_mfma_f32_32x32x16_bf16 v[192:207], v[28:31], a[100:103], v[192:207]
    ds_read_b128 v[116:119], v9 offset:29696
    s_add_u32 s67, s95, s91
    s_add_u32 s67, s67, 88064
    buffer_load_dwordx4 a[180:183], v2, s[32:35], s67 offen sc1
    v_mul_f32 v225, v225, v33
    v_mul_f32 v226, v226, v34
    v_mul_f32 v227, v227, v35
    s_waitcnt lgkmcnt(2)
    v_mfma_f32_32x32x16_bf16 v[192:207], v[48:51], a[104:107], v[192:207]
    ds_read_b128 v[24:27], v9 offset:30720
    v_cvt_pk_bf16_f32 v56, v224, v225
    v_cvt_pk_bf16_f32 v57, v226, v227
    v_mul_f32 v36, v228, v228
    v_mfma_f32_32x32x16_bf16 v[192:207], v[52:55], a[108:111], v[192:207]
    ds_read_b128 v[28:31], v9 offset:31744
    buffer_load_dwordx4 a[188:191], v2, s[32:35], s67 offen offset:1024 sc1
    v_mul_f32 v37, v229, v229
    v_mul_f32 v38, v230, v230
    v_mul_f32 v39, v231, v231
    s_waitcnt lgkmcnt(2)
    v_mfma_f32_32x32x16_bf16 v[192:207], v[112:115], a[112:115], v[192:207]
    s_barrier
    ds_read_b128 v[48:51], v9 offset:32768
    v_fma_f32 v36, v36, v21, v20
    v_fma_f32 v37, v37, v21, v20
    v_fma_f32 v38, v38, v21, v20
    v_mfma_f32_32x32x16_bf16 v[192:207], v[116:119], a[116:119], v[192:207]
    ds_read_b128 v[52:55], v9 offset:33792
    buffer_load_dwordx4 a[196:199], v2, s[32:35], s67 offen offset:2048 sc1
    v_fma_f32 v39, v39, v21, v20
    v_mul_f32 v36, v36, v228
    v_mul_f32 v37, v37, v229
    s_waitcnt lgkmcnt(2)
    v_mfma_f32_32x32x16_bf16 v[192:207], v[24:27], a[120:123], v[192:207]
    ds_read_b128 v[112:115], v9 offset:34816
    v_mul_f32 v38, v38, v230
    v_mul_f32 v39, v39, v231
    v_exp_f32 v36, v36
    v_mfma_f32_32x32x16_bf16 v[192:207], v[28:31], a[124:127], v[192:207]
    ds_read_b128 v[116:119], v9 offset:35840
    buffer_load_dwordx4 a[204:207], v2, s[32:35], s67 offen offset:3072 sc1
    v_mul_f32 v228, v228, v236
    v_exp_f32 v37, v37
    v_mul_f32 v229, v229, v237
    s_waitcnt lgkmcnt(2)
    v_mfma_f32_32x32x16_bf16 v[208:223], v[48:51], a[0:3], 0
    ds_read_b128 v[24:27], v9 offset:36864
    v_exp_f32 v38, v38
    v_mul_f32 v230, v230, v238
    v_exp_f32 v39, v39
    v_mfma_f32_32x32x16_bf16 v[208:223], v[52:55], a[4:7], v[208:223]
    ds_read_b128 v[28:31], v9 offset:37888
    s_add_u32 s67, s95, s92
    buffer_load_dwordx4 a[224:227], v2, s[32:35], s67 offen sc1
    v_mul_f32 v231, v231, v239
    v_fma_f32 v36, v36, v19, v19
    v_fma_f32 v37, v37, v19, v19
    s_waitcnt lgkmcnt(2)
    v_mfma_f32_32x32x16_bf16 v[208:223], v[112:115], a[8:11], v[208:223]
    ds_read_b128 v[48:51], v9 offset:38912
    v_fma_f32 v38, v38, v19, v19
    v_fma_f32 v39, v39, v19, v19
    v_rcp_f32 v36, v36
    v_mfma_f32_32x32x16_bf16 v[208:223], v[116:119], a[12:15], v[208:223]
    ds_read_b128 v[52:55], v9 offset:39936
    buffer_load_dwordx4 a[232:235], v2, s[32:35], s67 offen offset:1024 sc1
    v_rcp_f32 v37, v37
    v_rcp_f32 v38, v38
    v_rcp_f32 v39, v39
    s_waitcnt lgkmcnt(2)
    v_mfma_f32_32x32x16_bf16 v[208:223], v[24:27], a[16:19], v[208:223]
    ds_read_b128 v[112:115], v9 offset:40960
    v_mul_f32 v228, v228, v36
    v_mul_f32 v229, v229, v37
    v_mul_f32 v230, v230, v38
    v_mfma_f32_32x32x16_bf16 v[208:223], v[28:31], a[20:23], v[208:223]
    ds_read_b128 v[116:119], v9 offset:41984
    buffer_load_dwordx4 a[240:243], v2, s[32:35], s67 offen offset:2048 sc1
    v_mul_f32 v231, v231, v39
    v_cvt_pk_bf16_f32 v58, v228, v229
    v_cvt_pk_bf16_f32 v59, v230, v231
    s_waitcnt lgkmcnt(2)
    v_mfma_f32_32x32x16_bf16 v[208:223], v[48:51], a[24:27], v[208:223]
    ds_read_b128 v[24:27], v9 offset:43008
    buffer_store_dwordx4 v[56:59], v2, s[32:35], s63 offen offset:2048 sc1
    s_waitcnt vmcnt(15)
    buffer_store_dwordx2 v[4:5], v249, s[32:35], s64 offen offset:8
    buffer_store_dwordx2 v[4:5], v250, s[32:35], s64 offen offset:8 sc1
    v_mul_f32 v32, v192, v192
    v_mfma_f32_32x32x16_bf16 v[208:223], v[52:55], a[28:31], v[208:223]
    ds_read_b128 v[28:31], v9 offset:44032
    buffer_load_dwordx4 a[248:251], v2, s[32:35], s67 offen offset:3072 sc1
    v_mul_f32 v33, v193, v193
    v_mul_f32 v34, v194, v194
    v_mul_f32 v35, v195, v195
    s_waitcnt lgkmcnt(2)
    v_mfma_f32_32x32x16_bf16 v[208:223], v[112:115], a[32:35], v[208:223]
    ds_read_b128 v[48:51], v9 offset:45056
    v_fma_f32 v32, v32, v21, v20
    v_fma_f32 v33, v33, v21, v20
    v_fma_f32 v34, v34, v21, v20
    v_mfma_f32_32x32x16_bf16 v[208:223], v[116:119], a[36:39], v[208:223]
    ds_read_b128 v[52:55], v9 offset:46080
    s_add_u32 s67, s95, s92
    s_add_u32 s67, s67, 88064
    buffer_load_dwordx4 a[228:231], v2, s[32:35], s67 offen sc1
    v_fma_f32 v35, v35, v21, v20
    v_mul_f32 v32, v32, v192
    v_mul_f32 v33, v33, v193
    s_waitcnt lgkmcnt(2)
    v_mfma_f32_32x32x16_bf16 v[208:223], v[24:27], a[40:43], v[208:223]
    ds_read_b128 v[112:115], v9 offset:47104
    v_mul_f32 v34, v34, v194
    v_mul_f32 v35, v35, v195
    v_exp_f32 v32, v32
    v_mfma_f32_32x32x16_bf16 v[208:223], v[28:31], a[44:47], v[208:223]
    ds_read_b128 v[116:119], v9 offset:48128
    buffer_load_dwordx4 a[236:239], v2, s[32:35], s67 offen offset:1024 sc1
    v_mul_f32 v192, v192, v200
    v_exp_f32 v33, v33
    v_mul_f32 v193, v193, v201
    s_waitcnt lgkmcnt(2)
    v_mfma_f32_32x32x16_bf16 v[208:223], v[48:51], a[48:51], v[208:223]
    ds_read_b128 v[24:27], v9 offset:49152
    v_exp_f32 v34, v34
    v_mul_f32 v194, v194, v202
    v_exp_f32 v35, v35
    v_mfma_f32_32x32x16_bf16 v[208:223], v[52:55], a[52:55], v[208:223]
    ds_read_b128 v[28:31], v9 offset:50176
    buffer_load_dwordx4 a[244:247], v2, s[32:35], s67 offen offset:2048 sc1
    v_mul_f32 v195, v195, v203
    v_fma_f32 v32, v32, v19, v19
    v_fma_f32 v33, v33, v19, v19
    s_waitcnt lgkmcnt(2)
    v_mfma_f32_32x32x16_bf16 v[208:223], v[112:115], a[56:59], v[208:223]
    ds_read_b128 v[48:51], v9 offset:51200
    v_fma_f32 v34, v34, v19, v19
    v_fma_f32 v35, v35, v19, v19
    v_rcp_f32 v32, v32
    v_mfma_f32_32x32x16_bf16 v[208:223], v[116:119], a[60:63], v[208:223]
    ds_read_b128 v[52:55], v9 offset:52224
    buffer_load_dwordx4 a[252:255], v2, s[32:35], s67 offen offset:3072 sc1
    v_rcp_f32 v33, v33
    v_rcp_f32 v34, v34
    v_rcp_f32 v35, v35
    s_waitcnt lgkmcnt(2)
    v_mfma_f32_32x32x16_bf16 v[208:223], v[24:27], a[64:67], v[208:223]
    ds_read_b128 v[112:115], v9 offset:53248
    v_mul_f32 v192, v192, v32
    v_mul_f32 v193, v193, v33
    v_mul_f32 v194, v194, v34
    v_mfma_f32_32x32x16_bf16 v[208:223], v[28:31], a[68:71], v[208:223]
    ds_read_b128 v[116:119], v9 offset:54272
    s_add_u32 s67, s95, s93
    buffer_load_dwordx4 v[144:147], v2, s[32:35], s67 offen sc1
    v_mul_f32 v195, v195, v35
    v_cvt_pk_bf16_f32 v60, v192, v193
    v_cvt_pk_bf16_f32 v61, v194, v195
    s_waitcnt lgkmcnt(2)
    v_mfma_f32_32x32x16_bf16 v[208:223], v[48:51], a[72:75], v[208:223]
    ds_read_b128 v[24:27], v9 offset:55296
    v_mul_f32 v36, v196, v196
    v_mul_f32 v37, v197, v197
    v_mul_f32 v38, v198, v198
    v_mfma_f32_32x32x16_bf16 v[208:223], v[52:55], a[76:79], v[208:223]
    ds_read_b128 v[28:31], v9 offset:56320
    buffer_load_dwordx4 v[152:155], v2, s[32:35], s67 offen offset:1024 sc1
    v_mul_f32 v39, v199, v199
    v_fma_f32 v36, v36, v21, v20
    v_fma_f32 v37, v37, v21, v20
    s_waitcnt lgkmcnt(2)
    v_mfma_f32_32x32x16_bf16 v[208:223], v[112:115], a[80:83], v[208:223]
    ds_read_b128 v[48:51], v9 offset:57344
    v_fma_f32 v38, v38, v21, v20
    v_fma_f32 v39, v39, v21, v20
    v_mul_f32 v36, v36, v196
    v_mfma_f32_32x32x16_bf16 v[208:223], v[116:119], a[84:87], v[208:223]
    ds_read_b128 v[52:55], v9 offset:58368
    s_add_u32 s67, s95, s93
    s_add_u32 s67, s67, 88064
    buffer_load_dwordx4 v[148:151], v2, s[32:35], s67 offen sc1
    v_mul_f32 v37, v37, v197
    v_mul_f32 v38, v38, v198
    v_mul_f32 v39, v39, v199
    s_waitcnt lgkmcnt(2)
    v_mfma_f32_32x32x16_bf16 v[208:223], v[24:27], a[88:91], v[208:223]
    ds_read_b128 v[112:115], v9 offset:59392
    v_exp_f32 v36, v36
    v_mul_f32 v196, v196, v204
    v_exp_f32 v37, v37
    v_mfma_f32_32x32x16_bf16 v[208:223], v[28:31], a[92:95], v[208:223]
    ds_read_b128 v[116:119], v9 offset:60416
    buffer_load_dwordx4 v[156:159], v2, s[32:35], s67 offen offset:1024 sc1
    v_mul_f32 v197, v197, v205
    v_exp_f32 v38, v38
    v_mul_f32 v198, v198, v206
    s_waitcnt lgkmcnt(2)
    v_mfma_f32_32x32x16_bf16 v[208:223], v[48:51], a[96:99], v[208:223]
    ds_read_b128 v[24:27], v9 offset:61440
    v_exp_f32 v39, v39
    v_mul_f32 v199, v199, v207
    v_fma_f32 v36, v36, v19, v19
    v_mfma_f32_32x32x16_bf16 v[208:223], v[52:55], a[100:103], v[208:223]
    ds_read_b128 v[28:31], v9 offset:62464
    s_add_u32 s67, s95, s90
    s_add_u32 s67, s67, 4096
    buffer_load_dwordx4 a[160:163], v2, s[32:35], s67 offen sc1
    v_fma_f32 v37, v37, v19, v19
    v_fma_f32 v38, v38, v19, v19
    v_fma_f32 v39, v39, v19, v19
    s_waitcnt lgkmcnt(2)
    v_mfma_f32_32x32x16_bf16 v[208:223], v[112:115], a[104:107], v[208:223]
    ds_read_b128 v[48:51], v9 offset:63488
    v_rcp_f32 v36, v36
    v_rcp_f32 v37, v37
    v_rcp_f32 v38, v38
    v_mfma_f32_32x32x16_bf16 v[208:223], v[116:119], a[108:111], v[208:223]
    ds_read_b128 v[52:55], v9 offset:64512
    buffer_load_dwordx4 a[168:171], v2, s[32:35], s67 offen offset:1024 sc1
    v_rcp_f32 v39, v39
    v_mul_f32 v196, v196, v36
    v_mul_f32 v197, v197, v37
    s_waitcnt lgkmcnt(2)
    v_mfma_f32_32x32x16_bf16 v[208:223], v[24:27], a[112:115], v[208:223]
    s_barrier
    ds_read_b128 v[112:115], v11 offset:0
    v_mul_f32 v198, v198, v38
    v_mul_f32 v199, v199, v39
    v_cvt_pk_bf16_f32 v62, v196, v197
    v_mfma_f32_32x32x16_bf16 v[208:223], v[28:31], a[116:119], v[208:223]
    ds_read_b128 v[116:119], v11 offset:1024
    s_add_u32 s67, s95, s90
    s_add_u32 s67, s67, 92160
    buffer_load_dwordx4 a[164:167], v2, s[32:35], s67 offen sc1
    v_cvt_pk_bf16_f32 v63, v198, v199
    buffer_store_dwordx4 v[60:63], v2, s[32:35], s63 offen offset:3072 sc1
    s_waitcnt vmcnt(15)
    buffer_store_dwordx2 v[4:5], v249, s[32:35], s64 offen offset:16
    buffer_store_dwordx2 v[4:5], v250, s[32:35], s64 offen offset:16 sc1
    s_waitcnt lgkmcnt(2)
    v_mfma_f32_32x32x16_bf16 v[208:223], v[48:51], a[120:123], v[208:223]
    ds_read_b128 v[24:27], v11 offset:2048
    v_mfma_f32_32x32x16_bf16 v[208:223], v[52:55], a[124:127], v[208:223]
    ds_read_b128 v[28:31], v11 offset:3072
    buffer_load_dwordx4 a[172:175], v2, s[32:35], s67 offen offset:1024 sc1
    s_waitcnt lgkmcnt(2)
    v_mfma_f32_32x32x16_bf16 v[224:239], v[112:115], a[0:3], 0
    ds_read_b128 v[48:51], v11 offset:4096
    v_mfma_f32_32x32x16_bf16 v[224:239], v[116:119], a[4:7], v[224:239]
    ds_read_b128 v[52:55], v11 offset:5120
    s_add_u32 s67, s95, s91
    s_add_u32 s67, s67, 4096
    buffer_load_dwordx4 a[208:211], v2, s[32:35], s67 offen sc1
    s_nop 1
    v_mul_f32 v32, v208, v208
    v_mul_f32 v33, v209, v209
    s_waitcnt lgkmcnt(2)
    v_mfma_f32_32x32x16_bf16 v[224:239], v[24:27], a[8:11], v[224:239]
    ds_read_b128 v[112:115], v11 offset:6144
    v_mul_f32 v34, v210, v210
    v_mul_f32 v35, v211, v211
    v_mfma_f32_32x32x16_bf16 v[224:239], v[28:31], a[12:15], v[224:239]
    ds_read_b128 v[116:119], v11 offset:7168
    buffer_load_dwordx4 a[216:219], v2, s[32:35], s67 offen offset:1024 sc1
    v_fma_f32 v32, v32, v21, v20
    v_fma_f32 v33, v33, v21, v20
    v_fma_f32 v34, v34, v21, v20
    s_waitcnt lgkmcnt(2)
    v_mfma_f32_32x32x16_bf16 v[224:239], v[48:51], a[16:19], v[224:239]
    ds_read_b128 v[24:27], v11 offset:8192
    v_fma_f32 v35, v35, v21, v20
    v_mul_f32 v32, v32, v208
    v_mfma_f32_32x32x16_bf16 v[224:239], v[52:55], a[20:23], v[224:239]
    ds_read_b128 v[28:31], v11 offset:9216
    s_add_u32 s67, s95, s91
    s_add_u32 s67, s67, 92160
    buffer_load_dwordx4 a[212:215], v2, s[32:35], s67 offen sc1
    v_mul_f32 v33, v33, v209
    v_mul_f32 v34, v34, v210
    s_waitcnt lgkmcnt(2)
    v_mfma_f32_32x32x16_bf16 v[224:239], v[112:115], a[24:27], v[224:239]
    ds_read_b128 v[48:51], v11 offset:10240
    v_mul_f32 v35, v35, v211
    v_exp_f32 v32, v32
    v_mul_f32 v208, v208, v216
    v_mfma_f32_32x32x16_bf16 v[224:239], v[116:119], a[28:31], v[224:239]
    ds_read_b128 v[52:55], v11 offset:11264
    buffer_load_dwordx4 a[220:223], v2, s[32:35], s67 offen offset:1024 sc1
    v_exp_f32 v33, v33
    v_mul_f32 v209, v209, v217
    s_waitcnt lgkmcnt(2)
    v_mfma_f32_32x32x16_bf16 v[224:239], v[24:27], a[32:35], v[224:239]
    ds_read_b128 v[112:115], v11 offset:12288
    v_exp_f32 v34, v34
    v_mul_f32 v210, v210, v218
    v_exp_f32 v35, v35
    v_mfma_f32_32x32x16_bf16 v[224:239], v[28:31], a[36:39], v[224:239]
    ds_read_b128 v[116:119], v11 offset:13312
    s_add_u32 s67, s95, s92
    s_add_u32 s67, s67, 4096
    buffer_load_dwordx4 v[128:131], v2, s[32:35], s67 offen sc1
    v_mul_f32 v211, v211, v219
    v_fma_f32 v32, v32, v19, v19
    s_waitcnt lgkmcnt(2)
    v_mfma_f32_32x32x16_bf16 v[224:239], v[48:51], a[40:43], v[224:239]
    ds_read_b128 v[24:27], v11 offset:14336
    v_fma_f32 v33, v33, v19, v19
    v_fma_f32 v34, v34, v19, v19
    v_mfma_f32_32x32x16_bf16 v[224:239], v[52:55], a[44:47], v[224:239]
    ds_read_b128 v[28:31], v11 offset:15360
    buffer_load_dwordx4 v[136:139], v2, s[32:35], s67 offen offset:1024 sc1
    v_fma_f32 v35, v35, v19, v19
    v_rcp_f32 v32, v32
    v_rcp_f32 v33, v33
    s_waitcnt lgkmcnt(2)
    v_mfma_f32_32x32x16_bf16 v[224:239], v[112:115], a[48:51], v[224:239]
    ds_read_b128 v[48:51], v11 offset:16384
    v_rcp_f32 v34, v34
    v_rcp_f32 v35, v35
    v_mfma_f32_32x32x16_bf16 v[224:239], v[116:119], a[52:55], v[224:239]
    ds_read_b128 v[52:55], v11 offset:17408
    s_add_u32 s67, s95, s92
    s_add_u32 s67, s67, 92160
    buffer_load_dwordx4 v[132:135], v2, s[32:35], s67 offen sc1
    v_mul_f32 v208, v208, v32
    v_mul_f32 v209, v209, v33
    v_mul_f32 v210, v210, v34
    s_waitcnt lgkmcnt(2)
    v_mfma_f32_32x32x16_bf16 v[224:239], v[24:27], a[56:59], v[224:239]
    ds_read_b128 v[112:115], v11 offset:18432
    v_mul_f32 v211, v211, v35
    v_cvt_pk_bf16_f32 v56, v208, v209
    v_mfma_f32_32x32x16_bf16 v[224:239], v[28:31], a[60:63], v[224:239]
    ds_read_b128 v[116:119], v11 offset:19456
    buffer_load_dwordx4 v[140:143], v2, s[32:35], s67 offen offset:1024 sc1
    v_cvt_pk_bf16_f32 v57, v210, v211
    v_mul_f32 v36, v212, v212
    s_waitcnt lgkmcnt(2)
    v_mfma_f32_32x32x16_bf16 v[224:239], v[48:51], a[64:67], v[224:239]
    ds_read_b128 v[24:27], v11 offset:20480
    v_mul_f32 v37, v213, v213
    v_mul_f32 v38, v214, v214
    v_mul_f32 v39, v215, v215
    v_mfma_f32_32x32x16_bf16 v[224:239], v[52:55], a[68:71], v[224:239]
    ds_read_b128 v[28:31], v11 offset:21504
    v_fma_f32 v36, v36, v21, v20
    v_fma_f32 v37, v37, v21, v20
    s_waitcnt lgkmcnt(2)
    v_mfma_f32_32x32x16_bf16 v[224:239], v[112:115], a[72:75], v[224:239]
    ds_read_b128 v[48:51], v11 offset:22528
    v_fma_f32 v38, v38, v21, v20
    v_fma_f32 v39, v39, v21, v20
    v_mul_f32 v36, v36, v212
    v_mfma_f32_32x32x16_bf16 v[224:239], v[116:119], a[76:79], v[224:239]
    ds_read_b128 v[52:55], v11 offset:23552
    v_mul_f32 v37, v37, v213
    v_mul_f32 v38, v38, v214
    s_waitcnt lgkmcnt(2)
    v_mfma_f32_32x32x16_bf16 v[224:239], v[24:27], a[80:83], v[224:239]
    ds_read_b128 v[112:115], v11 offset:24576
    v_mul_f32 v39, v39, v215
    v_exp_f32 v36, v36
    v_mfma_f32_32x32x16_bf16 v[224:239], v[28:31], a[84:87], v[224:239]
    ds_read_b128 v[116:119], v11 offset:25600
    v_mul_f32 v212, v212, v220
    v_exp_f32 v37, v37
    v_mul_f32 v213, v213, v221
    s_waitcnt lgkmcnt(2)
    v_mfma_f32_32x32x16_bf16 v[224:239], v[48:51], a[88:91], v[224:239]
    ds_read_b128 v[24:27], v11 offset:26624
    v_exp_f32 v38, v38
    v_mul_f32 v214, v214, v222
    v_mfma_f32_32x32x16_bf16 v[224:239], v[52:55], a[92:95], v[224:239]
    ds_read_b128 v[28:31], v11 offset:27648
    v_exp_f32 v39, v39
    v_mul_f32 v215, v215, v223
    v_fma_f32 v36, v36, v19, v19
    s_waitcnt lgkmcnt(2)
    v_mfma_f32_32x32x16_bf16 v[224:239], v[112:115], a[96:99], v[224:239]
    ds_read_b128 v[48:51], v11 offset:28672
    s_waitcnt vmcnt(11)
    buffer_store_dwordx2 v[4:5], v249, s[32:35], s64 offen offset:24
    buffer_store_dwordx2 v[4:5], v250, s[32:35], s64 offen offset:24 sc1
    v_fma_f32 v37, v37, v19, v19
    v_mfma_f32_32x32x16_bf16 v[224:239], v[116:119], a[100:103], v[224:239]
    ds_read_b128 v[52:55], v11 offset:29696
    v_fma_f32 v38, v38, v19, v19
    v_fma_f32 v39, v39, v19, v19
    s_waitcnt lgkmcnt(2)
    v_mfma_f32_32x32x16_bf16 v[224:239], v[24:27], a[104:107], v[224:239]
    ds_read_b128 v[112:115], v11 offset:30720
    v_rcp_f32 v36, v36
    v_rcp_f32 v37, v37
    v_rcp_f32 v38, v38
    v_mfma_f32_32x32x16_bf16 v[224:239], v[28:31], a[108:111], v[224:239]
    ds_read_b128 v[116:119], v11 offset:31744
    v_rcp_f32 v39, v39
    v_mul_f32 v212, v212, v36
    s_waitcnt lgkmcnt(2)
    v_mfma_f32_32x32x16_bf16 v[224:239], v[48:51], a[112:115], v[224:239]
    v_mul_f32 v213, v213, v37
    v_mul_f32 v214, v214, v38
    v_mul_f32 v215, v215, v39
    v_mfma_f32_32x32x16_bf16 v[224:239], v[52:55], a[116:119], v[224:239]
    v_cvt_pk_bf16_f32 v58, v212, v213
    v_cvt_pk_bf16_f32 v59, v214, v215
    s_waitcnt lgkmcnt(0)
    v_mfma_f32_32x32x16_bf16 v[224:239], v[112:115], a[120:123], v[224:239]
    buffer_store_dwordx4 v[56:59], v2, s[32:35], s65 offen sc1
    v_mfma_f32_32x32x16_bf16 v[224:239], v[116:119], a[124:127], v[224:239]
    buffer_load_dwordx2 v[6:7], v18, s[32:35], s98 offen sc1
    s_nop 10
    v_mul_f32 v32, v224, v224
    v_mul_f32 v33, v225, v225
    v_mul_f32 v34, v226, v226
    v_mul_f32 v35, v227, v227
    v_fma_f32 v32, v32, v21, v20
    v_fma_f32 v33, v33, v21, v20
    s_add_u32 s67, s95, s87
    buffer_load_dwordx4 v[160:163], v2, s[32:35], s67 offen sc1
    v_fma_f32 v34, v34, v21, v20
    v_fma_f32 v35, v35, v21, v20
    v_mul_f32 v32, v32, v224
    v_mul_f32 v33, v33, v225
    v_mul_f32 v34, v34, v226
    v_mul_f32 v35, v35, v227
    s_add_u32 s67, s95, s87
    s_add_u32 s67, s67, 88064
    buffer_load_dwordx4 v[164:167], v2, s[32:35], s67 offen sc1
    v_exp_f32 v32, v32
    v_mul_f32 v224, v224, v232
    v_exp_f32 v33, v33
    v_mul_f32 v225, v225, v233
    v_exp_f32 v34, v34
    v_mul_f32 v226, v226, v234
    s_add_u32 s67, s95, s97
    buffer_load_dwordx4 v[168:171], v2, s[32:35], s67 offen sc1
    v_exp_f32 v35, v35
    v_mul_f32 v227, v227, v235
    v_fma_f32 v32, v32, v19, v19
    v_fma_f32 v33, v33, v19, v19
    v_fma_f32 v34, v34, v19, v19
    v_fma_f32 v35, v35, v19, v19
    s_add_u32 s67, s95, s97
    s_add_u32 s67, s67, 88064
    buffer_load_dwordx4 v[172:175], v2, s[32:35], s67 offen sc1
    v_rcp_f32 v32, v32
    v_rcp_f32 v33, v33
    v_rcp_f32 v34, v34
    v_rcp_f32 v35, v35
    v_mul_f32 v224, v224, v32
    v_mul_f32 v225, v225, v33
    v_mul_f32 v226, v226, v34
    v_mul_f32 v227, v227, v35
    v_cvt_pk_bf16_f32 v60, v224, v225
    v_cvt_pk_bf16_f32 v61, v226, v227
    v_mul_f32 v36, v228, v228
    v_mul_f32 v37, v229, v229
    v_mul_f32 v38, v230, v230
    v_mul_f32 v39, v231, v231
    v_fma_f32 v36, v36, v21, v20
    v_fma_f32 v37, v37, v21, v20
    v_fma_f32 v38, v38, v21, v20
    v_fma_f32 v39, v39, v21, v20
    v_mul_f32 v36, v36, v228
    v_mul_f32 v37, v37, v229
    v_mul_f32 v38, v38, v230
    v_mul_f32 v39, v39, v231
    v_exp_f32 v36, v36
    v_mul_f32 v228, v228, v236
    v_exp_f32 v37, v37
    v_mul_f32 v229, v229, v237
    v_exp_f32 v38, v38
    v_mul_f32 v230, v230, v238
    v_exp_f32 v39, v39
    v_mul_f32 v231, v231, v239
    v_fma_f32 v36, v36, v19, v19
    v_fma_f32 v37, v37, v19, v19
    v_fma_f32 v38, v38, v19, v19
    v_fma_f32 v39, v39, v19, v19
    v_rcp_f32 v36, v36
    v_rcp_f32 v37, v37
    v_rcp_f32 v38, v38
    v_rcp_f32 v39, v39
    v_mul_f32 v228, v228, v36
    v_mul_f32 v229, v229, v37
    v_mul_f32 v230, v230, v38
    v_mul_f32 v231, v231, v39
    v_cvt_pk_bf16_f32 v62, v228, v229
    v_cvt_pk_bf16_f32 v63, v230, v231
    buffer_store_dwordx4 v[60:63], v2, s[32:35], s65 offen offset:1024 sc1
    s_waitcnt vmcnt(5)
    v_cmp_ne_u64 vcc, v[6:7], v[4:5]
    s_cbranch_vccnz slow_13
back_14:
    s_add_u32 s67, s96, s90
    buffer_load_dwordx4 a[0:3], v2, s[32:35], s67 offen sc1
    buffer_load_dwordx4 a[4:7], v2, s[32:35], s67 offen offset:1024 sc1
    buffer_load_dwordx4 a[8:11], v2, s[32:35], s67 offen offset:2048 sc1
    buffer_load_dwordx4 a[12:15], v2, s[32:35], s67 offen offset:3072 sc1
    s_add_u32 s67, s96, s91
    buffer_load_dwordx4 a[24:27], v2, s[32:35], s67 offen sc1
    buffer_load_dwordx4 a[28:31], v2, s[32:35], s67 offen offset:1024 sc1
    buffer_load_dwordx4 a[32:35], v2, s[32:35], s67 offen offset:2048 sc1
    buffer_load_dwordx4 a[36:39], v2, s[32:35], s67 offen offset:3072 sc1
    s_branch p3done_10
p3short_9:
    v_mfma_f32_32x32x16_bf16 v[208:223], v[28:31], a[120:123], v[208:223]
    s_waitcnt lgkmcnt(1)
    v_mfma_f32_32x32x16_bf16 v[192:207], v[48:51], a[124:127], v[192:207]
    s_waitcnt lgkmcnt(0)
    v_mfma_f32_32x32x16_bf16 v[208:223], v[52:55], a[124:127], v[208:223]
    v_mul_f32 v20, 0xc0135761, v41
    v_mul_f32 v41, v41, v41
    v_mul_f32 v41, 0x3d372713, v41
    v_mul_f32 v21, v20, v41
    s_nop 5
    v_mul_f32 v32, v192, v192
    v_mul_f32 v33, v193, v193
    v_mul_f32 v34, v194, v194
    v_mul_f32 v35, v195, v195
    v_fma_f32 v32, v32, v21, v20
    v_fma_f32 v33, v33, v21, v20
    v_fma_f32 v34, v34, v21, v20
    v_fma_f32 v35, v35, v21, v20
    v_mul_f32 v32, v32, v192
    v_mul_f32 v33, v33, v193
    v_mul_f32 v34, v34, v194
    v_mul_f32 v35, v35, v195
    v_exp_f32 v32, v32
    v_mul_f32 v192, v192, v200
    v_exp_f32 v33, v33
    v_mul_f32 v193, v193, v201
    v_exp_f32 v34, v34
    v_mul_f32 v194, v194, v202
    v_exp_f32 v35, v35
    v_mul_f32 v195, v195, v203
    v_fma_f32 v32, v32, v19, v19
    v_fma_f32 v33, v33, v19, v19
    v_fma_f32 v34, v34, v19, v19
    v_fma_f32 v35, v35, v19, v19
    v_rcp_f32 v32, v32
    v_rcp_f32 v33, v33
    v_rcp_f32 v34, v34
    v_rcp_f32 v35, v35
    v_mul_f32 v192, v192, v32
    v_mul_f32 v193, v193, v33
    v_mul_f32 v194, v194, v34
    v_mul_f32 v195, v195, v35
    v_cvt_pk_bf16_f32 v56, v192, v193
    v_cvt_pk_bf16_f32 v57, v194, v195
    v_mul_f32 v36, v196, v196
    v_mul_f32 v37, v197, v197
    v_mul_f32 v38, v198, v198
    v_mul_f32 v39, v199, v199
    v_fma_f32 v36, v36, v21, v20
    v_fma_f32 v37, v37, v21, v20
    v_fma_f32 v38, v38, v21, v20
    v_fma_f32 v39, v39, v21, v20
    v_mul_f32 v36, v36, v196
    v_mul_f32 v37, v37, v197
    v_mul_f32 v38, v38, v198
    v_mul_f32 v39, v39, v199
    v_exp_f32 v36, v36
    v_mul_f32 v196, v196, v204
    v_exp_f32 v37, v37
    v_mul_f32 v197, v197, v205
    v_exp_f32 v38, v38
    v_mul_f32 v198, v198, v206
    v_exp_f32 v39, v39
    v_mul_f32 v199, v199, v207
    v_fma_f32 v36, v36, v19, v19
    v_fma_f32 v37, v37, v19, v19
    v_fma_f32 v38, v38, v19, v19
    v_fma_f32 v39, v39, v19, v19
    v_rcp_f32 v36, v36
    v_rcp_f32 v37, v37
    v_rcp_f32 v38, v38
    v_rcp_f32 v39, v39
    v_mul_f32 v196, v196, v36
    v_mul_f32 v197, v197, v37
    v_mul_f32 v198, v198, v38
    v_mul_f32 v199, v199, v39
    v_cvt_pk_bf16_f32 v58, v196, v197
    v_cvt_pk_bf16_f32 v59, v198, v199
    buffer_store_dwordx4 v[56:59], v2, s[32:35], s63 offen sc1
    v_mul_f32 v32, v208, v208
    v_mul_f32 v33, v209, v209
    v_mul_f32 v34, v210, v210
    v_mul_f32 v35, v211, v211
    v_fma_f32 v32, v32, v21, v20
    v_fma_f32 v33, v33, v21, v20
    v_fma_f32 v34, v34, v21, v20
    v_fma_f32 v35, v35, v21, v20
    v_mul_f32 v32, v32, v208
    v_mul_f32 v33, v33, v209
    v_mul_f32 v34, v34, v210
    v_mul_f32 v35, v35, v211
    v_exp_f32 v32, v32
    v_mul_f32 v208, v208, v216
    v_exp_f32 v33, v33
    v_mul_f32 v209, v209, v217
    v_exp_f32 v34, v34
    v_mul_f32 v210, v210, v218
    v_exp_f32 v35, v35
    v_mul_f32 v211, v211, v219
    v_fma_f32 v32, v32, v19, v19
    v_fma_f32 v33, v33, v19, v19
    v_fma_f32 v34, v34, v19, v19
    v_fma_f32 v35, v35, v19, v19
    v_rcp_f32 v32, v32
    v_rcp_f32 v33, v33
    v_rcp_f32 v34, v34
    v_rcp_f32 v35, v35
    v_mul_f32 v208, v208, v32
    v_mul_f32 v209, v209, v33
    v_mul_f32 v210, v210, v34
    v_mul_f32 v211, v211, v35
    v_cvt_pk_bf16_f32 v60, v208, v209
    v_cvt_pk_bf16_f32 v61, v210, v211
    v_mul_f32 v36, v212, v212
    v_mul_f32 v37, v213, v213
    v_mul_f32 v38, v214, v214
    v_mul_f32 v39, v215, v215
    v_fma_f32 v36, v36, v21, v20
    v_fma_f32 v37, v37, v21, v20
    v_fma_f32 v38, v38, v21, v20
    v_fma_f32 v39, v39, v21, v20
    v_mul_f32 v36, v36, v212
    v_mul_f32 v37, v37, v213
    v_mul_f32 v38, v38, v214
    v_mul_f32 v39, v39, v215
    v_exp_f32 v36, v36
    v_mul_f32 v212, v212, v220
    v_exp_f32 v37, v37
    v_mul_f32 v213, v213, v221
    v_exp_f32 v38, v38
    v_mul_f32 v214, v214, v222
    v_exp_f32 v39, v39
    v_mul_f32 v215, v215, v223
    v_fma_f32 v36, v36, v19, v19
    v_fma_f32 v37, v37, v19, v19
    v_fma_f32 v38, v38, v19, v19
    v_fma_f32 v39, v39, v19, v19
    v_rcp_f32 v36, v36
    v_rcp_f32 v37, v37
    v_rcp_f32 v38, v38
    v_rcp_f32 v39, v39
    v_mul_f32 v212, v212, v36
    v_mul_f32 v213, v213, v37
    v_mul_f32 v214, v214, v38
    v_mul_f32 v215, v215, v39
    v_cvt_pk_bf16_f32 v62, v212, v213
    v_cvt_pk_bf16_f32 v63, v214, v215
    buffer_store_dwordx4 v[60:63], v2, s[32:35], s63 offen offset:1024 sc1
    s_waitcnt vmcnt(0)
    buffer_store_dwordx2 v[4:5], v249, s[32:35], s64 offen
    buffer_store_dwordx2 v[4:5], v250, s[32:35], s64 offen sc1
    buffer_store_dwordx2 v[4:5], v249, s[32:35], s64 offen offset:8
    buffer_store_dwordx2 v[4:5], v250, s[32:35], s64 offen offset:8 sc1
    s_branch p3sk2_11
p3skip_8:
    s_mul_i32 s88, s99, 6
    s_mul_i32 s63, s92, 86
    s_add_u32 s63, s63, s88
    s_lshl_b32 s63, s63, 10
    s_add_u32 s63, s63, 5767168
    s_add_u32 s65, s63, 4096
    s_mul_i32 s64, s92, 96
    s_add_u32 s64, s64, s88
    s_lshl_b32 s64, s64, 3
    s_add_u32 s64, s64, 32768
    s_mul_i32 s89, s39, 43
    s_lshr_b32 s89, s89, 7
    s_mul_i32 s89, s89, 3
    s_sub_u32 s89, s39, s89
    s_mul_i32 s88, s36, 6
    s_mul_i32 s90, s89, 24
    s_add_u32 s90, s90, s88
    s_add_u32 s89, s89, 1
    s_cmp_eq_u32 s89, 3
    s_cselect_b32 s89, 0, s89
    s_mul_i32 s91, s89, 24
    s_add_u32 s91, s91, s88
    s_add_u32 s89, s89, 1
    s_cmp_eq_u32 s89, 3
    s_cselect_b32 s89, 0, s89
    s_mul_i32 s92, s89, 24
    s_add_u32 s92, s92, s88
    s_add_u32 s89, s89, 1
    s_cmp_eq_u32 s89, 3
    s_cselect_b32 s89, 0, s89
    s_lshl_b32 s93, s36, 1
    s_cmp_ge_u32 s36, 2
    s_cselect_b32 s88, 2, 0
    s_cselect_b32 s87, 6, 0
    s_add_u32 s93, s93, s88
    s_add_u32 s93, s93, 72
    s_add_u32 s87, s87, s36
    s_add_u32 s87, s87, 76
    s_add_u32 s97, s36, 82
    s_mul_i32 s95, s39, 176128
    s_add_u32 s95, s95, 14680064
    s_mul_i32 s96, s41, 176128
    s_add_u32 s96, s96, 5767168
    v_min_u32 v14, 27, v1
    v_cmp_le_u32 vcc, 14, v14
    v_subrev_u32 v15, 14, v14
    v_mov_b32 v13, 96
    v_cndmask_b32 v14, v14, v15, vcc
    v_cndmask_b32 v12, 0, v13, vcc
    v_and_b32 v15, 3, v14
    v_cmp_le_u32 vcc, 4, v14
    v_add_u32 v18, s90, v15
    v_add_u32 v13, s91, v15
    v_cndmask_b32 v18, v18, v13, vcc
    v_cmp_le_u32 vcc, 8, v14
    v_add_u32 v13, s92, v15
    v_add_u32 v16, s93, v15
    v_cndmask_b32 v18, v18, v13, vcc
    v_cmp_le_u32 vcc, 12, v14
    v_and_b32 v14, 7, v1
    v_and_b32 v15, 1, v1
    v_cndmask_b32 v18, v18, v16, vcc
    v_add_u32 v18, v18, v12
    v_lshlrev_b32 v18, 3, v18
    v_cmp_le_u32 vcc, 2, v14
    v_add_u32 v15, 4, v15
    v_add_u32 v16, s90, v15
    v_add_u32 v13, s91, v15
    v_cndmask_b32 v16, v16, v13, vcc
    v_cmp_le_u32 vcc, 4, v14
    v_add_u32 v13, s92, v15
    v_bfe_u32 v12, v1, 3, 1
    v_cndmask_b32 v16, v16, v13, vcc
    v_cmp_eq_u32 vcc, 6, v14
    v_mov_b32 v13, s87
    v_mul_u32_u24 v12, 96, v12
    v_cndmask_b32 v16, v16, v13, vcc
    v_cmp_eq_u32 vcc, 7, v14
    v_mov_b32 v13, s97
    s_mul_i32 s98, s41, 1536
    v_cndmask_b32 v16, v16, v13, vcc
    v_add_u32 v16, v16, v12
    v_lshlrev_b32 v16, 3, v16
    s_add_u32 s98, s98, 32768
    s_lshl_b32 s90, s90, 10
    s_lshl_b32 s91, s91, 10
    s_lshl_b32 s92, s92, 10
    s_lshl_b32 s93, s93, 10
    s_lshl_b32 s87, s87, 10
    s_lshl_b32 s97, s97, 10
    v_and_b32 v14, 31, v1
    v_mul_u32_u24 v14, 272, v14
    v_lshrrev_b32 v15, 5, v1
    v_lshl_add_u32 v14, v15, 4, v14
    s_mul_i32 s88, s36, 8704
    v_add_u32 v12, s88, v14
    s_mul_i32 s88, s45, 43520
    s_lshl_b32 s89, s46, 7
    s_add_u32 s88, s88, s89
    s_add_u32 s88, s88, 34816
    v_add_u32 v121, s88, v14
    v_lshrrev_b32 v14, 3, v1
    v_and_b32 v15, 7, v1
    v_mul_u32_u24 v13, 272, v14
    v_lshl_add_u32 v13, v15, 5, v13
    s_mul_i32 s88, s36, 2176
    v_add_u32 v13, s88, v13
    v_add_u32 v120, 43520, v13
    v_lshlrev_b32 v10, 10, v14
    v_lshl_add_u32 v10, v15, 4, v10
    s_lshl_b32 s60, s41, 3
    s_add_u32 s60, s60, s36
    s_lshl_b32 s60, s60, 13
    s_lshl_b32 s88, s39, 7
    s_add_u32 s60, s60, s88
    s_add_u32 s61, s60, 32768
p3sk2_11:
    s_add_u32 s67, s95, s90
    buffer_load_dwordx4 a[128:131], v2, s[32:35], s67 offen sc1
    buffer_load_dwordx4 a[136:139], v2, s[32:35], s67 offen offset:1024 sc1
    buffer_load_dwordx4 a[144:147], v2, s[32:35], s67 offen offset:2048 sc1
    buffer_load_dwordx4 a[152:155], v2, s[32:35], s67 offen offset:3072 sc1
    s_add_u32 s67, s95, s90
    s_add_u32 s67, s67, 88064
    buffer_load_dwordx4 a[132:135], v2, s[32:35], s67 offen sc1
    buffer_load_dwordx4 a[140:143], v2, s[32:35], s67 offen offset:1024 sc1
    buffer_load_dwordx4 a[148:151], v2, s[32:35], s67 offen offset:2048 sc1
    buffer_load_dwordx4 a[156:159], v2, s[32:35], s67 offen offset:3072 sc1
    s_add_u32 s67, s95, s91
    buffer_load_dwordx4 a[176:179], v2, s[32:35], s67 offen sc1
    buffer_load_dwordx4 a[184:187], v2, s[32:35], s67 offen offset:1024 sc1
    buffer_load_dwordx4 a[192:195], v2, s[32:35], s67 offen offset:2048 sc1
    buffer_load_dwordx4 a[200:203], v2, s[32:35], s67 offen offset:3072 sc1
    s_add_u32 s67, s95, s91
    s_add_u32 s67, s67, 88064
    buffer_load_dwordx4 a[180:183], v2, s[32:35], s67 offen sc1
    buffer_load_dwordx4 a[188:191], v2, s[32:35], s67 offen offset:1024 sc1
    buffer_load_dwordx4 a[196:199], v2, s[32:35], s67 offen offset:2048 sc1
    buffer_load_dwordx4 a[204:207], v2, s[32:35], s67 offen offset:3072 sc1
    s_add_u32 s67, s95, s92
    buffer_load_dwordx4 a[224:227], v2, s[32:35], s67 offen sc1
    buffer_load_dwordx4 a[232:235], v2, s[32:35], s67 offen offset:1024 sc1
    buffer_load_dwordx4 a[240:243], v2, s[32:35], s67 offen offset:2048 sc1
    buffer_load_dwordx4 a[248:251], v2, s[32:35], s67 offen offset:3072 sc1
    s_add_u32 s67, s95, s92
    s_add_u32 s67, s67, 88064
    buffer_load_dwordx4 a[228:231], v2, s[32:35], s67 offen sc1
    buffer_load_dwordx4 a[236:239], v2, s[32:35], s67 offen offset:1024 sc1
    buffer_load_dwordx4 a[244:247], v2, s[32:35], s67 offen offset:2048 sc1
    buffer_load_dwordx4 a[252:255], v2, s[32:35], s67 offen offset:3072 sc1
    s_add_u32 s67, s95, s93
    buffer_load_dwordx4 v[144:147], v2, s[32:35], s67 offen sc1
    buffer_load_dwordx4 v[152:155], v2, s[32:35], s67 offen offset:1024 sc1
    s_add_u32 s67, s95, s93
    s_add_u32 s67, s67, 88064
    buffer_load_dwordx4 v[148:151], v2, s[32:35], s67 offen sc1
    buffer_load_dwordx4 v[156:159], v2, s[32:35], s67 offen offset:1024 sc1
    s_add_u32 s67, s95, s90
    s_add_u32 s67, s67, 4096
    buffer_load_dwordx4 a[160:163], v2, s[32:35], s67 offen sc1
    buffer_load_dwordx4 a[168:171], v2, s[32:35], s67 offen offset:1024 sc1
    s_add_u32 s67, s95, s90
    s_add_u32 s67, s67, 92160
    buffer_load_dwordx4 a[164:167], v2, s[32:35], s67 offen sc1
    buffer_load_dwordx4 a[172:175], v2, s[32:35], s67 offen offset:1024 sc1
    s_add_u32 s67, s95, s91
    s_add_u32 s67, s67, 4096
    buffer_load_dwordx4 a[208:211], v2, s[32:35], s67 offen sc1
    buffer_load_dwordx4 a[216:219], v2, s[32:35], s67 offen offset:1024 sc1
    s_add_u32 s67, s95, s91
    s_add_u32 s67, s67, 92160
    buffer_load_dwordx4 a[212:215], v2, s[32:35], s67 offen sc1
    buffer_load_dwordx4 a[220:223], v2, s[32:35], s67 offen offset:1024 sc1
    s_add_u32 s67, s95, s92
    s_add_u32 s67, s67, 4096
    buffer_load_dwordx4 v[128:131], v2, s[32:35], s67 offen sc1
    buffer_load_dwordx4 v[136:139], v2, s[32:35], s67 offen offset:1024 sc1
    s_add_u32 s67, s95, s92
    s_add_u32 s67, s67, 92160
    buffer_load_dwordx4 v[132:135], v2, s[32:35], s67 offen sc1
    buffer_load_dwordx4 v[140:143], v2, s[32:35], s67 offen offset:1024 sc1
    s_add_u32 s67, s95, s87
    buffer_load_dwordx4 v[160:163], v2, s[32:35], s67 offen sc1
    s_add_u32 s67, s95, s87
    s_add_u32 s67, s67, 88064
    buffer_load_dwordx4 v[164:167], v2, s[32:35], s67 offen sc1
    s_add_u32 s67, s95, s97
    buffer_load_dwordx4 v[168:171], v2, s[32:35], s67 offen sc1
    s_add_u32 s67, s95, s97
    s_add_u32 s67, s67, 88064
    buffer_load_dwordx4 v[172:175], v2, s[32:35], s67 offen sc1
    s_mov_b32 s68, 0
poll_15:
    buffer_load_dwordx2 v[6:7], v18, s[32:35], s98 offen sc1
    s_add_u32 s68, s68, 1
    s_cmp_gt_u32 s68, 400000
    s_cbranch_scc1 L_end
    s_waitcnt vmcnt(0)
    v_cmp_ne_u64 vcc, v[6:7], v[4:5]
    s_cbranch_vccnz poll_15
    s_add_u32 s67, s96, s90
    buffer_load_dwordx4 a[0:3], v2, s[32:35], s67 offen sc1
    buffer_load_dwordx4 a[4:7], v2, s[32:35], s67 offen offset:1024 sc1
    buffer_load_dwordx4 a[8:11], v2, s[32:35], s67 offen offset:2048 sc1
    buffer_load_dwordx4 a[12:15], v2, s[32:35], s67 offen offset:3072 sc1
    s_add_u32 s67, s96, s91
    buffer_load_dwordx4 a[24:27], v2, s[32:35], s67 offen sc1
    buffer_load_dwordx4 a[28:31], v2, s[32:35], s67 offen offset:1024 sc1
    buffer_load_dwordx4 a[32:35], v2, s[32:35], s67 offen offset:2048 sc1
    buffer_load_dwordx4 a[36:39], v2, s[32:35], s67 offen offset:3072 sc1
    s_mov_b32 s64, 0x7f000000
    s_waitcnt vmcnt(0) lgkmcnt(0)
p3done_10:
    s_waitcnt vmcnt(7)
    v_mfma_f32_32x32x16_bf16 v[192:207], a[128:131], a[0:3], 0
    s_add_u32 s67, s96, s92
    buffer_load_dwordx4 a[48:51], v2, s[32:35], s67 offen sc1
    buffer_load_dwordx4 a[52:55], v2, s[32:35], s67 offen offset:1024 sc1
    buffer_load_dwordx4 a[56:59], v2, s[32:35], s67 offen offset:2048 sc1
    v_mfma_f32_32x32x16_bf16 v[224:239], a[132:135], a[0:3], 0
    s_waitcnt vmcnt(9)
    v_mfma_f32_32x32x16_bf16 v[192:207], a[136:139], a[4:7], v[192:207]
    buffer_load_dwordx4 a[60:63], v2, s[32:35], s67 offen offset:3072 sc1
    v_mfma_f32_32x32x16_bf16 v[224:239], a[140:143], a[4:7], v[224:239]
    buffer_store_dwordx2 v[4:5], v249, s[32:35], s64 offen offset:32
    buffer_store_dwordx2 v[4:5], v250, s[32:35], s64 offen offset:32 sc1
    buffer_store_dwordx2 v[4:5], v249, s[32:35], s64 offen offset:40
    buffer_store_dwordx2 v[4:5], v250, s[32:35], s64 offen offset:40 sc1
    s_waitcnt vmcnt(13)
    v_mfma_f32_32x32x16_bf16 v[192:207], a[144:147], a[8:11], v[192:207]
    v_mfma_f32_32x32x16_bf16 v[224:239], a[148:151], a[8:11], v[224:239]
    s_waitcnt vmcnt(12)
    v_mfma_f32_32x32x16_bf16 v[192:207], a[152:155], a[12:15], v[192:207]
    v_mfma_f32_32x32x16_bf16 v[224:239], a[156:159], a[12:15], v[224:239]
    s_waitcnt vmcnt(11)
    v_mfma_f32_32x32x16_bf16 v[192:207], a[176:179], a[24:27], v[192:207]
    v_mfma_f32_32x32x16_bf16 v[224:239], a[180:183], a[24:27], v[224:239]
    s_waitcnt vmcnt(10)
    v_mfma_f32_32x32x16_bf16 v[192:207], a[184:187], a[28:31], v[192:207]
    v_mfma_f32_32x32x16_bf16 v[224:239], a[188:191], a[28:31], v[224:239]
    s_waitcnt vmcnt(9)
    v_mfma_f32_32x32x16_bf16 v[192:207], a[192:195], a[32:35], v[192:207]
    s_add_u32 s67, s96, s93
    buffer_load_dwordx4 a[72:75], v2, s[32:35], s67 offen sc1
    v_lshlrev_b32 v24, 16, v240
    v_mfma_f32_32x32x16_bf16 v[224:239], a[196:199], a[32:35], v[224:239]
    v_and_b32 v25, s69, v240
    s_waitcnt vmcnt(9)
    v_mfma_f32_32x32x16_bf16 v[192:207], a[200:203], a[36:39], v[192:207]
    buffer_load_dwordx4 a[76:79], v2, s[32:35], s67 offen offset:1024 sc1
    v_lshlrev_b32 v26, 16, v241
    v_mfma_f32_32x32x16_bf16 v[224:239], a[204:207], a[36:39], v[224:239]
    v_and_b32 v27, s69, v241
    s_waitcnt vmcnt(9)
    v_mfma_f32_32x32x16_bf16 v[192:207], a[224:227], a[48:51], v[192:207]
    s_add_u32 s67, s96, s90
    s_add_u32 s67, s67, 88064
    buffer_load_dwordx4 a[88:91], v2, s[32:35], s67 offen sc1
    v_lshlrev_b32 v28, 16, v242
    v_mfma_f32_32x32x16_bf16 v[224:239], a[228:231], a[48:51], v[224:239]
    v_and_b32 v29, s69, v242
    s_waitcnt vmcnt(9)
    v_mfma_f32_32x32x16_bf16 v[192:207], a[232:235], a[52:55], v[192:207]
    buffer_load_dwordx4 a[92:95], v2, s[32:35], s67 offen offset:1024 sc1
    v_lshlrev_b32 v30, 16, v243
    v_mfma_f32_32x32x16_bf16 v[224:239], a[236:239], a[52:55], v[224:239]
    v_and_b32 v31, s69, v243
    s_waitcnt vmcnt(9)
    v_mfma_f32_32x32x16_bf16 v[192:207], a[240:243], a[56:59], v[192:207]
    buffer_load_dwordx4 a[96:99], v2, s[32:35], s67 offen offset:2048 sc1
    v_lshlrev_b32 v32, 16, v244
    v_mfma_f32_32x32x16_bf16 v[224:239], a[244:247], a[56:59], v[224:239]
    v_and_b32 v33, s69, v244
    s_waitcnt vmcnt(9)
    v_mfma_f32_32x32x16_bf16 v[192:207], a[248:251], a[60:63], v[192:207]
    buffer_load_dwordx4 a[100:103], v2, s[32:35], s67 offen offset:3072 sc1
    v_lshlrev_b32 v34, 16, v245
    v_mfma_f32_32x32x16_bf16 v[224:239], a[252:255], a[60:63], v[224:239]
    v_and_b32 v35, s69, v245
    s_waitcnt vmcnt(5)
    v_mfma_f32_32x32x16_bf16 v[192:207], v[144:147], a[72:75], v[192:207]
    buffer_load_dwordx2 v[6:7], v16, s[32:35], s98 offen sc1
    s_add_u32 s67, s96, s91
    s_add_u32 s67, s67, 88064
    buffer_load_dwordx4 a[112:115], v2, s[32:35], s67 offen sc1
    buffer_load_dwordx4 a[116:119], v2, s[32:35], s67 offen offset:1024 sc1
    buffer_load_dwordx4 a[120:123], v2, s[32:35], s67 offen offset:2048 sc1
    buffer_load_dwordx4 a[124:127], v2, s[32:35], s67 offen offset:3072 sc1
    v_lshlrev_b32 v36, 16, v246
    v_mfma_f32_32x32x16_bf16 v[224:239], v[148:151], a[72:75], v[224:239]
    v_and_b32 v37, s69, v246
    s_waitcnt vmcnt(9)
    v_mfma_f32_32x32x16_bf16 v[192:207], v[152:155], a[76:79], v[192:207]
    s_add_u32 s67, s96, s92
    s_add_u32 s67, s67, 88064
    buffer_load_dwordx4 v[72:75], v2, s[32:35], s67 offen sc1
    v_lshlrev_b32 v38, 16, v247
    v_mfma_f32_32x32x16_bf16 v[224:239], v[156:159], a[76:79], v[224:239]
    v_and_b32 v39, s69, v247
    s_waitcnt vmcnt(9)
    v_mfma_f32_32x32x16_bf16 v[208:223], a[128:131], a[88:91], 0
    buffer_load_dwordx4 v[76:79], v2, s[32:35], s67 offen offset:1024 sc1
    ds_write_b128 v121, v[24:27] offset:0
    v_mfma_f32_32x32x16_bf16 v[176:191], a[132:135], a[88:91], 0
    ds_write_b128 v121, v[28:31] offset:32
    s_waitcnt vmcnt(9)
    v_mfma_f32_32x32x16_bf16 v[208:223], a[136:139], a[92:95], v[208:223]
    buffer_load_dwordx4 v[80:83], v2, s[32:35], s67 offen offset:2048 sc1
    ds_write_b128 v121, v[32:35] offset:64
    v_mfma_f32_32x32x16_bf16 v[176:191], a[140:143], a[92:95], v[176:191]
    ds_write_b128 v121, v[36:39] offset:96
    s_waitcnt vmcnt(9)
    v_mfma_f32_32x32x16_bf16 v[208:223], a[144:147], a[96:99], v[208:223]
    buffer_load_dwordx4 v[84:87], v2, s[32:35], s67 offen offset:3072 sc1
    v_mfma_f32_32x32x16_bf16 v[176:191], a[148:151], a[96:99], v[176:191]
    s_waitcnt vmcnt(9)
    v_mfma_f32_32x32x16_bf16 v[208:223], a[152:155], a[100:103], v[208:223]
    v_mfma_f32_32x32x16_bf16 v[176:191], a[156:159], a[100:103], v[176:191]
    s_waitcnt vmcnt(8)
    v_cmp_ne_u64 vcc, v[6:7], v[4:5]
    s_cbranch_vccnz slow_16
back_17:
    s_waitcnt vmcnt(7)
    v_mfma_f32_32x32x16_bf16 v[208:223], a[176:179], a[112:115], v[208:223]
    s_add_u32 s67, s96, s90
    s_add_u32 s67, s67, 4096
    buffer_load_dwordx4 a[16:19], v2, s[32:35], s67 offen sc1
    buffer_load_dwordx4 a[20:23], v2, s[32:35], s67 offen offset:1024 sc1
    s_add_u32 s67, s96, s91
    s_add_u32 s67, s67, 4096
    buffer_load_dwordx4 a[40:43], v2, s[32:35], s67 offen sc1
    v_mfma_f32_32x32x16_bf16 v[176:191], a[180:183], a[112:115], v[176:191]
    s_waitcnt vmcnt(9)
    v_mfma_f32_32x32x16_bf16 v[208:223], a[184:187], a[116:119], v[208:223]
    buffer_load_dwordx4 a[44:47], v2, s[32:35], s67 offen offset:1024 sc1
    v_mfma_f32_32x32x16_bf16 v[176:191], a[188:191], a[116:119], v[176:191]
    s_waitcnt vmcnt(9)
    v_mfma_f32_32x32x16_bf16 v[208:223], a[192:195], a[120:123], v[208:223]
    s_add_u32 s67, s96, s92
    s_add_u32 s67, s67, 4096
    buffer_load_dwordx4 a[64:67], v2, s[32:35], s67 offen sc1
    v_mfma_f32_32x32x16_bf16 v[176:191], a[196:199], a[120:123], v[176:191]
    s_waitcnt vmcnt(9)
    v_mfma_f32_32x32x16_bf16 v[208:223], a[200:203], a[124:127], v[208:223]
    buffer_load_dwordx4 a[68:71], v2, s[32:35], s67 offen offset:1024 sc1
    v_mfma_f32_32x32x16_bf16 v[176:191], a[204:207], a[124:127], v[176:191]
    s_waitcnt vmcnt(9)
    v_mfma_f32_32x32x16_bf16 v[208:223], a[224:227], v[72:75], v[208:223]
    s_add_u32 s67, s96, s87
    buffer_load_dwordx4 a[80:83], v2, s[32:35], s67 offen sc1
    v_mfma_f32_32x32x16_bf16 v[176:191], a[228:231], v[72:75], v[176:191]
    s_waitcnt vmcnt(9)
    v_mfma_f32_32x32x16_bf16 v[208:223], a[232:235], v[76:79], v[208:223]
    s_add_u32 s67, s96, s97
    buffer_load_dwordx4 a[84:87], v2, s[32:35], s67 offen sc1
    v_mfma_f32_32x32x16_bf16 v[176:191], a[236:239], v[76:79], v[176:191]
    s_waitcnt vmcnt(9)
    v_mfma_f32_32x32x16_bf16 v[208:223], a[240:243], v[80:83], v[208:223]
    s_add_u32 s67, s96, s93
    s_add_u32 s67, s67, 88064
    buffer_load_dwordx4 v[96:99], v2, s[32:35], s67 offen sc1
    v_mfma_f32_32x32x16_bf16 v[176:191], a[244:247], v[80:83], v[176:191]
    s_waitcnt vmcnt(9)
    v_mfma_f32_32x32x16_bf16 v[208:223], a[248:251], v[84:87], v[208:223]
    buffer_load_dwordx4 v[100:103], v2, s[32:35], s67 offen offset:1024 sc1
    v_mfma_f32_32x32x16_bf16 v[176:191], a[252:255], v[84:87], v[176:191]
    s_waitcnt vmcnt(9)
    v_mfma_f32_32x32x16_bf16 v[192:207], a[160:163], a[16:19], v[192:207]
    s_add_u32 s67, s96, s90
    s_add_u32 s67, s67, 92160
    buffer_load_dwordx4 a[104:107], v2, s[32:35], s67 offen sc1
    v_mfma_f32_32x32x16_bf16 v[224:239], a[164:167], a[16:19], v[224:239]
    s_waitcnt vmcnt(9)
    v_mfma_f32_32x32x16_bf16 v[192:207], a[168:171], a[20:23], v[192:207]
    buffer_load_dwordx4 a[108:111], v2, s[32:35], s67 offen offset:1024 sc1
    v_mfma_f32_32x32x16_bf16 v[224:239], a[172:175], a[20:23], v[224:239]
    s_waitcnt vmcnt(9)
    v_mfma_f32_32x32x16_bf16 v[192:207], a[208:211], a[40:43], v[192:207]
    s_add_u32 s67, s96, s91
    s_add_u32 s67, s67, 92160
    buffer_load_dwordx4 v[64:67], v2, s[32:35], s67 offen sc1
    v_mfma_f32_32x32x16_bf16 v[224:239], a[212:215], a[40:43], v[224:239]
    s_waitcnt vmcnt(9)
    v_mfma_f32_32x32x16_bf16 v[192:207], a[216:219], a[44:47], v[192:207]
    buffer_load_dwordx4 v[68:71], v2, s[32:35], s67 offen offset:1024 sc1
    v_mfma_f32_32x32x16_bf16 v[224:239], a[220:223], a[44:47], v[224:239]
    s_waitcnt vmcnt(9)
    v_mfma_f32_32x32x16_bf16 v[192:207], v[128:131], a[64:67], v[192:207]
    s_add_u32 s67, s96, s92
    s_add_u32 s67, s67, 92160
    buffer_load_dwordx4 v[88:91], v2, s[32:35], s67 offen sc1
    v_mfma_f32_32x32x16_bf16 v[224:239], v[132:135], a[64:67], v[224:239]
    s_waitcnt vmcnt(9)
    v_mfma_f32_32x32x16_bf16 v[192:207], v[136:139], a[68:71], v[192:207]
    buffer_load_dwordx4 v[92:95], v2, s[32:35], s67 offen offset:1024 sc1
    v_mfma_f32_32x32x16_bf16 v[224:239], v[140:143], a[68:71], v[224:239]
    s_waitcnt vmcnt(9)
    v_mfma_f32_32x32x16_bf16 v[192:207], v[160:163], a[80:83], v[192:207]
    s_add_u32 s67, s96, s87
    s_add_u32 s67, s67, 88064
    buffer_load_dwordx4 v[104:107], v2, s[32:35], s67 offen sc1
    v_mfma_f32_32x32x16_bf16 v[224:239], v[164:167], a[80:83], v[224:239]
    s_cmp_ge_u32 s36, 2
    s_cbranch_scc1 p4s_18
    s_waitcnt vmcnt(9)
    v_mfma_f32_32x32x16_bf16 v[192:207], v[168:171], a[84:87], v[192:207]
    v_mfma_f32_32x32x16_bf16 v[224:239], v[172:175], a[84:87], v[224:239]
p4s_18:
    s_waitcnt vmcnt(8)
    v_mfma_f32_32x32x16_bf16 v[208:223], v[144:147], v[96:99], v[208:223]
    s_add_u32 s67, s96, s97
    s_add_u32 s67, s67, 88064
    buffer_load_dwordx4 v[108:111], v2, s[32:35], s67 offen sc1
    v_mfma_f32_32x32x16_bf16 v[176:191], v[148:151], v[96:99], v[176:191]
    s_waitcnt vmcnt(8)
    v_mfma_f32_32x32x16_bf16 v[208:223], v[152:155], v[100:103], v[208:223]
    s_nop 2
    ds_write_b128 v12, v[192:195] offset:0
    ds_write_b128 v12, v[196:199] offset:32
    ds_write_b128 v12, v[200:203] offset:64
    v_mfma_f32_32x32x16_bf16 v[176:191], v[156:159], v[100:103], v[176:191]
    ds_write_b128 v12, v[204:207] offset:96
    ds_write_b128 v12, v[224:227] offset:128
    ds_write_b128 v12, v[228:231] offset:160
    s_waitcnt vmcnt(7)
    v_mfma_f32_32x32x16_bf16 v[208:223], a[160:163], a[104:107], v[208:223]
    ds_write_b128 v12, v[232:235] offset:192
    ds_write_b128 v12, v[236:239] offset:224
    s_waitcnt lgkmcnt(0)
    s_barrier
    v_mfma_f32_32x32x16_bf16 v[176:191], a[164:167], a[104:107], v[176:191]
    ds_read_b128 v[24:27], v13 offset:0
    ds_read_b128 v[28:31], v13 offset:16
    ds_read_b128 v[32:35], v13 offset:8704
    s_waitcnt vmcnt(6)
    v_mfma_f32_32x32x16_bf16 v[208:223], a[168:171], a[108:111], v[208:223]
    ds_read_b128 v[36:39], v13 offset:8720
    ds_read_b128 v[40:43], v13 offset:17408
    ds_read_b128 v[44:47], v13 offset:17424
    v_mfma_f32_32x32x16_bf16 v[176:191], a[172:175], a[108:111], v[176:191]
    ds_read_b128 v[48:51], v13 offset:26112
    ds_read_b128 v[52:55], v13 offset:26128
    ds_read_b128 v[56:59], v13 offset:34816
    s_waitcnt vmcnt(5)
    v_mfma_f32_32x32x16_bf16 v[208:223], a[208:211], v[64:67], v[208:223]
    ds_read_b128 v[60:63], v13 offset:34832
    s_waitcnt lgkmcnt(0)
    v_add_f32 v24, v24, v32
    v_mfma_f32_32x32x16_bf16 v[176:191], a[212:215], v[64:67], v[176:191]
    v_add_f32 v40, v40, v48
    v_add_f32 v25, v25, v33
    v_add_f32 v41, v41, v49
    s_waitcnt vmcnt(4)
    v_mfma_f32_32x32x16_bf16 v[208:223], a[216:219], v[68:71], v[208:223]
    v_add_f32 v26, v26, v34
    v_add_f32 v42, v42, v50
    v_add_f32 v27, v27, v35
    v_mfma_f32_32x32x16_bf16 v[176:191], a[220:223], v[68:71], v[176:191]
    v_add_f32 v43, v43, v51
    v_add_f32 v28, v28, v36
    v_add_f32 v44, v44, v52
    s_waitcnt vmcnt(3)
    v_mfma_f32_32x32x16_bf16 v[208:223], v[128:131], v[88:91], v[208:223]
    v_add_f32 v29, v29, v37
    v_add_f32 v45, v45, v53
    v_add_f32 v30, v30, v38
    v_mfma_f32_32x32x16_bf16 v[176:191], v[132:135], v[88:91], v[176:191]
    v_add_f32 v46, v46, v54
    v_add_f32 v31, v31, v39
    v_add_f32 v47, v47, v55
    s_waitcnt vmcnt(2)
    v_mfma_f32_32x32x16_bf16 v[208:223], v[136:139], v[92:95], v[208:223]
    v_add_f32 v24, v24, v56
    v_add_f32 v25, v25, v57
    v_add_f32 v26, v26, v58
    v_mfma_f32_32x32x16_bf16 v[176:191], v[140:143], v[92:95], v[176:191]
    v_add_f32 v27, v27, v59
    v_add_f32 v28, v28, v60
    v_add_f32 v29, v29, v61
    s_waitcnt vmcnt(1)
    v_mfma_f32_32x32x16_bf16 v[208:223], v[160:163], v[104:107], v[208:223]
    v_add_f32 v30, v30, v62
    v_add_f32 v31, v31, v63
    v_add_f32 v24, v24, v40
    v_mfma_f32_32x32x16_bf16 v[176:191], v[164:167], v[104:107], v[176:191]
    v_add_f32 v25, v25, v41
    v_add_f32 v26, v26, v42
    v_add_f32 v27, v27, v43
    v_add_f32 v28, v28, v44
    v_add_f32 v29, v29, v45
    v_add_f32 v30, v30, v46
    v_add_f32 v31, v31, v47
    v_cvt_pk_bf16_f32 v32, v24, v25
    v_cvt_pk_bf16_f32 v33, v26, v27
    v_cvt_pk_bf16_f32 v34, v28, v29
    v_cvt_pk_bf16_f32 v35, v30, v31
    buffer_store_dwordx4 v[32:35], v10, s[28:31], s60 offen
    s_cmp_ge_u32 s36, 2
    s_cbranch_scc1 p4s_19
    s_waitcnt vmcnt(1)
    v_mfma_f32_32x32x16_bf16 v[208:223], v[168:171], v[108:111], v[208:223]
    v_mfma_f32_32x32x16_bf16 v[176:191], v[172:175], v[108:111], v[176:191]
p4s_19:
    s_nop 10
    ds_write_b128 v12, v[208:211] offset:43520
    ds_write_b128 v12, v[212:215] offset:43552
    ds_write_b128 v12, v[216:219] offset:43584
    ds_write_b128 v12, v[220:223] offset:43616
    ds_write_b128 v12, v[176:179] offset:43648
    ds_write_b128 v12, v[180:183] offset:43680
    ds_write_b128 v12, v[184:187] offset:43712
    ds_write_b128 v12, v[188:191] offset:43744
    s_waitcnt lgkmcnt(0)
    s_barrier
    ds_read_b128 v[96:99], v120 offset:34816
    ds_read_b128 v[100:103], v120 offset:34832
    ds_read_b128 v[64:67], v120 offset:0
    ds_read_b128 v[68:71], v120 offset:16
    ds_read_b128 v[72:75], v120 offset:8704
    ds_read_b128 v[76:79], v120 offset:8720
    ds_read_b128 v[80:83], v120 offset:17408
    ds_read_b128 v[84:87], v120 offset:17424
    ds_read_b128 v[88:91], v120 offset:26112
    ds_read_b128 v[92:95], v120 offset:26128
    s_waitcnt lgkmcnt(6)
    v_pk_add_f32 v[64:65], v[64:65], v[96:97]
    v_pk_add_f32 v[66:67], v[66:67], v[98:99]
    v_pk_add_f32 v[68:69], v[68:69], v[100:101]
    v_pk_add_f32 v[70:71], v[70:71], v[102:103]
    s_waitcnt lgkmcnt(2)
    v_pk_add_f32 v[72:73], v[72:73], v[80:81]
    v_pk_add_f32 v[74:75], v[74:75], v[82:83]
    v_pk_add_f32 v[76:77], v[76:77], v[84:85]
    v_pk_add_f32 v[78:79], v[78:79], v[86:87]
    s_waitcnt lgkmcnt(0)
    v_pk_add_f32 v[64:65], v[64:65], v[88:89]
    v_pk_add_f32 v[66:67], v[66:67], v[90:91]
    v_pk_add_f32 v[68:69], v[68:69], v[92:93]
    v_pk_add_f32 v[70:71], v[70:71], v[94:95]
    v_pk_add_f32 v[64:65], v[64:65], v[72:73]
    v_pk_add_f32 v[66:67], v[66:67], v[74:75]
    v_pk_add_f32 v[68:69], v[68:69], v[76:77]
    v_pk_add_f32 v[70:71], v[70:71], v[78:79]
    v_cvt_pk_bf16_f32 v72, v64, v65
    v_cvt_pk_bf16_f32 v73, v66, v67
    v_cvt_pk_bf16_f32 v74, v68, v69
    v_cvt_pk_bf16_f32 v75, v70, v71
    buffer_store_dwordx4 v[72:75], v10, s[28:31], s61 offen
L_end:
    s_endpgm
slow_6:
    s_mov_b32 s68, 0
poll_20:
    buffer_load_dwordx2 v[14:15], v16, s[32:35], s98 offen sc1
    s_add_u32 s68, s68, 1
    s_cmp_gt_u32 s68, 400000
    s_cbranch_scc1 L_end
    s_waitcnt vmcnt(0)
    v_cmp_ne_u64 vcc, v[14:15], v[4:5]
    s_cbranch_vccnz poll_20
    s_nop 4
    s_branch back_7
slow_13:
    s_mov_b32 s68, 0
poll_21:
    buffer_load_dwordx2 v[6:7], v18, s[32:35], s98 offen sc1
    s_add_u32 s68, s68, 1
    s_cmp_gt_u32 s68, 400000
    s_cbranch_scc1 L_end
    s_waitcnt vmcnt(0)
    v_cmp_ne_u64 vcc, v[6:7], v[4:5]
    s_cbranch_vccnz poll_21
    s_nop 4
    s_branch back_14
slow_16:
    s_mov_b32 s68, 0
poll_22:
    buffer_load_dwordx2 v[6:7], v16, s[32:35], s98 offen sc1
    s_add_u32 s68, s68, 1
    s_cmp_gt_u32 s68, 400000
    s_cbranch_scc1 L_end
    s_waitcnt vmcnt(0)
    v_cmp_ne_u64 vcc, v[6:7], v[4:5]
    s_cbranch_vccnz poll_22
    s_nop 4
    s_branch back_17
.section .rodata,"a"
.p2align 6
.amdhsa_kernel sequential_preLN__linear_attn_block__geglu_ffn__prompt_kernel
  .amdhsa_next_free_vgpr 512
  .amdhsa_next_free_sgpr 102
  .amdhsa_accum_offset 256
  .amdhsa_group_segment_fixed_size 0
  .amdhsa_kernarg_size 80
  .amdhsa_user_sgpr_count 2
  .amdhsa_user_sgpr_kernarg_segment_ptr 1
  .amdhsa_system_sgpr_workgroup_id_x 1
.end_amdhsa_kernel
```
